```python
import torch

def _softmax(x, axis=-1):
    return torch.softmax(x, dim=axis)
def _gelu(x):
    return torch.nn.functional.gelu(x, approximate="tanh")
def _silu(x):
    return torch.nn.functional.silu(x)
def _sigmoid(x):
    return torch.sigmoid(x)
def _layernorm(x, axis=-1, eps=1e-5):
    m = x.mean(dim=axis, keepdim=True)
    v = x.var(dim=axis, keepdim=True, unbiased=False)
    return (x - m) / torch.sqrt(v + eps)
def _scatter_add(tgt, idx, src, axis=0):
    return tgt.clone().index_add_(axis, idx, src)
def _segment_sum(src, seg, n):
    out = torch.zeros((n,) + src.shape[1:], dtype=src.dtype)
    return out.index_add_(0, seg, src)
def _pad(x, pw):
    flat = tuple(v for pair in reversed(pw) for v in pair)
    return torch.nn.functional.pad(x, flat)

kernel_name = 'concat_heads__gqa_block_cached__gqa_block_cached__near_ridge'

def setup_inputs():

    _w = (lambda a: (lambda t: t.to(torch.bfloat16) if t.is_floating_point() else t)(torch.as_tensor(a)))
    def _A_setup():
        B, Sq, D = 8, 80, 512
        Hq, Hkv, Sk, Dh = 32, 8, 2048, 128
        assert Hq % Hkv == 0, (Hq, Hkv)
        return {
            "x": _w((lambda *s: torch.randn(*s, dtype=torch.bfloat16) * 0.8)(B, Sq, D)),
            "k_cache": _w((lambda *s: torch.randn(*s, dtype=torch.bfloat16) * 0.8)(B, Hkv, Sk, Dh)),
            "v_cache": _w((lambda *s: torch.randn(*s, dtype=torch.bfloat16) * 0.05)(B, Hkv, Sk, Dh)),
            "wq": _w((lambda *s: torch.randn(*s, dtype=torch.bfloat16) * 0.8)(D, Hq * Dh) * (D ** -0.5)),
            "wo": _w((lambda *s: torch.randn(*s, dtype=torch.bfloat16) * 0.05)(Hq * Dh, D) * ((Hq * Dh) ** -0.5)),
        }
    _A_in = _A_setup()

    def _B_setup():
        B, Sq, D = 8, 80, 512
        Hq, Hkv, Sk, Dh = 32, 8, 2048, 128
        assert Hq % Hkv == 0, (Hq, Hkv)
        return {
            "x": _w((lambda *s: torch.randn(*s, dtype=torch.bfloat16) * 0.8)(B, Sq, D)),
            "k_cache": _w((lambda *s: torch.randn(*s, dtype=torch.bfloat16) * 0.8)(B, Hkv, Sk, Dh)),
            "v_cache": _w((lambda *s: torch.randn(*s, dtype=torch.bfloat16) * 0.05)(B, Hkv, Sk, Dh)),
            "wq": _w((lambda *s: torch.randn(*s, dtype=torch.bfloat16) * 0.8)(D, Hq * Dh) * (D ** -0.5)),
            "wo": _w((lambda *s: torch.randn(*s, dtype=torch.bfloat16) * 0.05)(Hq * Dh, D) * ((Hq * Dh) ** -0.5)),
        }
    _B_in = _B_setup()

    return {
        "A_x": _A_in["x"],
        "A_k_cache": _A_in["k_cache"],
        "A_v_cache": _A_in["v_cache"],
        "A_wq": _A_in["wq"],
        "A_wo": _A_in["wo"],
        "B_x": _B_in["x"],
        "B_k_cache": _B_in["k_cache"],
        "B_v_cache": _B_in["v_cache"],
        "B_wq": _B_in["wq"],
        "B_wo": _B_in["wo"],
    }

def reference(A_x, A_k_cache, A_v_cache, A_wq, A_wo, B_x, B_k_cache, B_v_cache, B_wq, B_wo):
    def _A_ref(x, k_cache, v_cache, wq, wo):
        B, Sq, D = x.shape
        Hq, Dh = 32, 128
        Hkv = k_cache.shape[1]
        rep = Hq // Hkv
        q = (lambda x, *d: x.permute(*d))((x @ wq).reshape(B, Sq, Hq, Dh), 0, 2, 1, 3)
        k = (lambda x, n, axis: torch.repeat_interleave(x, n, dim=axis))(k_cache, rep, axis=1)
        v = (lambda x, n, axis: torch.repeat_interleave(x, n, dim=axis))(v_cache, rep, axis=1)
        scores = torch.einsum("bhqd,bhkd->bhqk", q, k) * (Dh ** -0.5)
        p = _softmax(scores, axis=-1)
        o = torch.einsum("bhqk,bhkd->bhqd", p, v)
        return (lambda x, *d: x.permute(*d))(o, 0, 2, 1, 3).reshape(B, Sq, Hq * Dh) @ wo

    def _B_ref(x, k_cache, v_cache, wq, wo):
        B, Sq, D = x.shape
        Hq, Dh = 32, 128
        Hkv = k_cache.shape[1]
        rep = Hq // Hkv
        q = (lambda x, *d: x.permute(*d))((x @ wq).reshape(B, Sq, Hq, Dh), 0, 2, 1, 3)
        k = (lambda x, n, axis: torch.repeat_interleave(x, n, dim=axis))(k_cache, rep, axis=1)
        v = (lambda x, n, axis: torch.repeat_interleave(x, n, dim=axis))(v_cache, rep, axis=1)
        scores = torch.einsum("bhqd,bhkd->bhqk", q, k) * (Dh ** -0.5)
        p = _softmax(scores, axis=-1)
        o = torch.einsum("bhqk,bhkd->bhqd", p, v)
        return (lambda x, *d: x.permute(*d))(o, 0, 2, 1, 3).reshape(B, Sq, Hq * Dh) @ wo

    a = _A_ref(A_x, A_k_cache, A_v_cache, A_wq, A_wo)
    b = _B_ref(B_x, B_k_cache, B_v_cache, B_wq, B_wo)
    return torch.concatenate([a, b], axis=-1)
```

```asm
; @launch grid=(256,1,1) block=(256,1,1) lds=163840
.amdgcn_target "amdgcn-amd-amdhsa--gfx950"
.text
.globl concat_heads__gqa_block_cached__gqa_block_cached__near_ridge_kernel
.p2align 8
.type concat_heads__gqa_block_cached__gqa_block_cached__near_ridge_kernel,@function
concat_heads__gqa_block_cached__gqa_block_cached__near_ridge_kernel:
    s_cmp_ge_u32 s2, 256
    s_cbranch_scc1 L_end
    s_mov_b32 s34, 0
L_top:
    s_load_dwordx16 s[36:51], s[0:1], 0
    s_load_dwordx4 s[52:55], s[0:1], 64
    s_load_dwordx2 s[24:25], s[0:1], 96
    s_load_dwordx2 s[100:101], s[0:1], 80
    s_getpc_b64 s[4:5]
    s_lshr_b32 s3, s2, 3
    v_lshrrev_b32 v1, 6, v0
    s_andn2_b32 s4, s4, 255
    v_lshl_add_u32 v1, s3, 2, v1
    s_mov_b32 s6, L_code_end-concat_heads__gqa_block_cached__gqa_block_cached__near_ridge_kernel
    v_and_b32 v2, 63, v0
    v_and_b32 v1, 31, v1
    s_mov_b32 s7, 0x20000
    v_lshl_add_u32 v1, v1, 4, v2
    v_lshlrev_b32 v1, 7, v1
    s_mov_b64 exec, 0xffff
    buffer_load_dword v255, v1, s[4:7], 0 offen
    s_mov_b64 exec, -1
    v_lshrrev_b32 v1, 6, v0
    v_and_b32 v0, 63, v0
    v_readfirstlane_b32 s26, v1
    v_and_b32 v1, 15, v0
    v_lshrrev_b32 v2, 4, v0
    s_and_b32 s30, s2, 7
    s_lshr_b32 s31, s2, 3
    s_lshr_b32 s35, s31, 2
    s_and_b32 s56, s30, 3
    s_lshl_b32 s56, s56, 1
    s_bfe_u32 s57, s31, 0x10001
    s_add_u32 s56, s56, s57
    s_and_b32 s57, s31, 1
    s_lshl_b32 s58, s56, 1
    s_add_u32 s57, s57, s58
    s_lshl_b32 s58, s35, 3
    s_add_u32 s58, s58, s56
    s_lshl_b32 s58, s58, 19
    s_mul_i32 s59, s35, 81920
    s_lshl_b32 s60, s57, 9
    s_and_b32 s61, s30, 3
    s_lshl_b32 s61, s61, 20
    s_lshl_b32 s27, s26, 12
    s_mul_i32 s96, s26, 5120
    s_lshr_b32 s62, s35, 1
    s_and_b32 s63, s31, 2
    s_add_u32 s62, s62, s63
    s_and_b32 s62, s62, 3
    s_lshl_b32 s97, s62, 8
    s_lshl_b32 s31, s62, 20
    s_and_b32 s62, s35, 1
    s_lshl_b32 s98, s62, 19
    s_xor_b32 s99, s31, s98
    v_lshrrev_b32 v3, 3, v0
    v_and_b32 v4, 7, v0
    v_bfe_u32 v5, v0, 4, 1
    v_lshlrev_b32 v5, 2, v5
    v_xor_b32 v4, v4, v5
    v_lshlrev_b32 v4, 4, v4
    s_lshl_b32 s3, s26, 7
    v_lshl_add_u32 v4, v3, 13, v4
    v_add_u32 v25, s3, v4
    v_add_u32 v26, 64512, v25
    v_add_u32 v27, 129024, v25
    v_add_u32 v28, 193536, v25
    s_mul_i32 s62, s26, 20
    v_add_u32 v3, s62, v2
    v_add_u32 v4, 0, v3
    v_xor_b32 v5, v4, v1
    v_and_b32 v5, 15, v5
    v_lshlrev_b32 v5, 4, v5
    v_lshl_add_u32 v20, v4, 10, v5
    v_add_u32 v4, 4, v3
    v_xor_b32 v5, v4, v1
    v_and_b32 v5, 15, v5
    v_lshlrev_b32 v5, 4, v5
    v_add_u32 v4, 3, v3
    v_lshl_add_u32 v21, v4, 10, v5
    v_add_u32 v4, 8, v3
    v_xor_b32 v5, v4, v1
    v_and_b32 v5, 15, v5
    v_lshlrev_b32 v5, 4, v5
    v_add_u32 v4, 6, v3
    v_lshl_add_u32 v22, v4, 10, v5
    v_add_u32 v4, 12, v3
    v_xor_b32 v5, v4, v1
    v_and_b32 v5, 15, v5
    v_lshlrev_b32 v5, 4, v5
    v_add_u32 v4, 9, v3
    v_lshl_add_u32 v23, v4, 10, v5
    v_add_u32 v4, 16, v3
    v_xor_b32 v5, v4, v1
    v_and_b32 v5, 15, v5
    v_lshlrev_b32 v5, 4, v5
    v_lshl_add_u32 v24, v4, 10, v5
    s_mov_b32 s18, 81920
    s_mov_b32 s19, 0x20000
    s_sub_u32 s14, 0x400000, s60
    s_mov_b32 s15, 0x20000
    s_mov_b32 s6, 524288
    s_mov_b32 s7, 0x20000
    s_mov_b32 s10, 524288
    s_mov_b32 s11, 0x20000
    s_mov_b32 s22, 1048576
    s_mov_b32 s23, 0x20000
    s_add_u32 m0, s27, 98304
    s_cmp_ge_u32 s30, 4
    s_waitcnt lgkmcnt(0)
    s_cselect_b32 s12, s52, s42
    s_cselect_b32 s13, s53, s43
    s_cselect_b32 s16, s46, s36
    s_cselect_b32 s17, s47, s37
    s_cselect_b32 s4, s48, s38
    s_cselect_b32 s5, s49, s39
    s_cselect_b32 s8, s50, s40
    s_cselect_b32 s9, s51, s41
    s_cselect_b32 s20, s54, s44
    s_cselect_b32 s21, s55, s45
    s_add_u32 s12, s12, s60
    s_addc_u32 s13, s13, 0
    buffer_load_dwordx4 v25, s[12:15], s99 offen offset:0 lds
    buffer_load_dwordx4 v26, s[12:15], s99 offen offset:1024 lds
    buffer_load_dwordx4 v27, s[12:15], s99 offen offset:2048 lds
    buffer_load_dwordx4 v28, s[12:15], s99 offen offset:3072 lds
    s_add_u32 s31, s31, 262144
    s_and_b32 s31, s31, 0x3fffff
    s_xor_b32 s99, s31, s98
    s_add_u32 s16, s16, s59
    s_addc_u32 s17, s17, 0
    s_add_u32 m0, s96, 40960
    s_nop 0
    buffer_load_dwordx4 v20, s[16:19], s97 offen offset:0 lds
    buffer_load_dwordx4 v21, s[16:19], s97 offen offset:1024 lds
    buffer_load_dwordx4 v22, s[16:19], s97 offen offset:2048 lds
    buffer_load_dwordx4 v23, s[16:19], s97 offen offset:3072 lds
    s_add_u32 m0, s96, 45056
    s_nop 0
    buffer_load_dwordx4 v24, s[16:19], s97 offen offset:0 lds
    s_add_u32 s97, s97, 256
    s_and_b32 s97, s97, 0x3ff
    s_add_u32 s4, s4, s58
    s_addc_u32 s5, s5, 0
    s_add_u32 s8, s8, s58
    s_addc_u32 s9, s9, 0
    s_add_u32 s20, s20, s61
    s_addc_u32 s21, s21, 0
    v_add_u32 v3, 0, v2
    v_xor_b32 v3, v3, v1
    v_lshlrev_b32 v3, 4, v3
    v_lshl_add_u32 v3, v2, 8, v3
    v_add_u32 v76, s27, v3
    v_add_u32 v3, 4, v2
    v_xor_b32 v3, v3, v1
    v_lshlrev_b32 v3, 4, v3
    v_lshl_add_u32 v3, v2, 8, v3
    v_add_u32 v77, s27, v3
    v_add_u32 v3, 8, v2
    v_xor_b32 v3, v3, v1
    v_lshlrev_b32 v3, 4, v3
    v_lshl_add_u32 v3, v2, 8, v3
    v_add_u32 v78, s27, v3
    v_add_u32 v3, 12, v2
    v_xor_b32 v3, v3, v1
    v_lshlrev_b32 v3, 4, v3
    v_lshl_add_u32 v3, v2, 8, v3
    v_add_u32 v79, s27, v3
    v_add_u32 v3, 0, v2
    v_lshlrev_b32 v3, 1, v3
    v_xor_b32 v3, v3, v1
    v_lshlrev_b32 v3, 4, v3
    v_lshl_add_u32 v4, v2, 8, v3
    v_add_u32 v80, s27, v4
    v_add_u32 v3, 4, v2
    v_lshlrev_b32 v3, 1, v3
    v_xor_b32 v3, v3, v1
    v_lshlrev_b32 v3, 4, v3
    v_lshl_add_u32 v4, v2, 8, v3
    v_add_u32 v81, s27, v4
    v_and_b32 v3, 7, v0
    v_lshlrev_b32 v4, 1, v2
    v_xor_b32 v3, v3, v4
    v_lshrrev_b32 v5, 2, v3
    v_and_b32 v3, 3, v3
    v_lshlrev_b32 v3, 4, v3
    v_lshl_add_u32 v3, v5, 15, v3
    v_lshrrev_b32 v4, 3, v0
    v_lshl_add_u32 v82, v4, 10, v3
    v_add_u32 v83, 7168, v82
    v_add_u32 v84, 14336, v82
    v_add_u32 v85, 21504, v82
    v_add_u32 v3, 0, v2
    v_xor_b32 v3, v3, v1
    v_lshlrev_b32 v3, 4, v3
    v_lshl_add_u32 v64, v1, 8, v3
    v_add_u32 v3, 4, v2
    v_xor_b32 v3, v3, v1
    v_lshlrev_b32 v3, 4, v3
    v_lshl_add_u32 v65, v1, 8, v3
    v_add_u32 v3, 8, v2
    v_xor_b32 v3, v3, v1
    v_lshlrev_b32 v3, 4, v3
    v_lshl_add_u32 v66, v1, 8, v3
    v_add_u32 v3, 12, v2
    v_xor_b32 v3, v3, v1
    v_lshlrev_b32 v3, 4, v3
    v_lshl_add_u32 v67, v1, 8, v3
    s_lshr_b32 s3, s98, 12
    v_xor_b32 v8, s3, v64
    v_xor_b32 v9, s3, v65
    v_xor_b32 v10, s3, v66
    v_xor_b32 v11, s3, v67
    s_bfe_u32 s62, s2, 0x20003
    s_and_b32 s63, s35, 0
    s_xor_b32 s63, s63, s62
    s_and_b32 s3, s2, 3
    s_lshl2_add_u32 s57, s63, s3
    s_xor_b32 s3, s57, s26
    s_lshl_b32 s3, s3, 6
    s_lshl_b32 s62, s62, 18
    s_or_b32 s37, s3, s62
    s_lshl_b32 s62, s26, 16
    s_or_b32 s33, s37, s62
    s_lshl2_add_u32 s56, s2, s26
    s_mul_i32 s56, s56, 10240
    v_lshrrev_b32 v3, 2, v1
    v_and_b32 v4, 3, v1
    v_lshl_add_u32 v5, v2, 3, v3
    v_lshlrev_b32 v5, 7, v5
    v_lshl_add_u32 v5, v4, 4, v5
    s_add_u32 s3, s27, 65536
    v_add_u32 v5, s3, v5
    v_lshrrev_b32 v6, 1, v3
    v_xor_b32 v7, 0, v6
    v_lshl_add_u32 v16, v7, 6, v5
    v_add_u32 v18, 65536, v16
    v_xor_b32 v7, 1, v6
    v_lshl_add_u32 v17, v7, 6, v5
    v_add_u32 v19, 65536, v17
    v_lshl_add_u32 v5, v2, 2, v3
    v_bfe_u32 v6, v5, 1, 2
    v_lshlrev_b32 v5, 7, v5
    v_lshl_add_u32 v5, v4, 3, v5
    v_add_u32 v5, s27, v5
    v_xor_b32 v7, 0, v6
    v_lshl_add_u32 v86, v7, 5, v5
    v_add_u32 v61, 65536, v86
    v_xor_b32 v7, 1, v6
    v_lshl_add_u32 v87, v7, 5, v5
    v_add_u32 v62, 65536, v87
    v_xor_b32 v7, 2, v6
    v_lshl_add_u32 v88, v7, 5, v5
    v_add_u32 v63, 65536, v88
    v_xor_b32 v7, 3, v6
    v_lshl_add_u32 v89, v7, 5, v5
    v_add_u32 v95, 65536, v89
    v_lshl_add_u32 v5, v2, 2, v3
    v_and_b32 v6, 7, v5
    v_lshlrev_b32 v5, 8, v5
    v_lshl_add_u32 v5, v4, 3, v5
    s_and_b32 s3, s26, 1
    s_lshl_b32 s62, s3, 2
    s_lshl_b32 s32, s3, 13
    s_add_u32 s3, s32, 65536
    v_xor_b32 v6, s62, v6
    v_add_u32 v5, s3, v5
    v_xor_b32 v7, 0, v6
    v_lshl_add_u32 v68, v7, 5, v5
    v_xor_b32 v7, 1, v6
    v_lshl_add_u32 v69, v7, 5, v5
    v_xor_b32 v7, 2, v6
    v_lshl_add_u32 v70, v7, 5, v5
    v_xor_b32 v7, 3, v6
    v_lshl_add_u32 v71, v7, 5, v5
    v_xor_b32 v7, 4, v6
    v_lshl_add_u32 v72, v7, 5, v5
    v_xor_b32 v7, 5, v6
    v_lshl_add_u32 v73, v7, 5, v5
    v_xor_b32 v7, 6, v6
    v_lshl_add_u32 v74, v7, 5, v5
    v_xor_b32 v7, 7, v6
    v_lshl_add_u32 v75, v7, 5, v5
    v_add_u32 v64, s32, v64
    v_add_u32 v65, s32, v65
    v_add_u32 v66, s32, v66
    v_add_u32 v67, s32, v67
    s_xor_b32 s3, s26, 0
    s_mul_i32 s3, s3, 12288
    s_add_u32 s3, s3, 114688
    v_lshl_add_u32 v90, v0, 4, s3
    s_xor_b32 s3, s26, 1
    s_mul_i32 s3, s3, 12288
    s_add_u32 s3, s3, 114688
    v_lshl_add_u32 v91, v0, 4, s3
    s_xor_b32 s3, s26, 2
    s_mul_i32 s3, s3, 12288
    s_add_u32 s3, s3, 114688
    v_lshl_add_u32 v92, v0, 4, s3
    s_xor_b32 s3, s26, 3
    s_mul_i32 s3, s3, 12288
    s_add_u32 s3, s3, 114688
    v_lshl_add_u32 v93, v0, 4, s3
    s_and_b32 s3, s26, 2
    s_mul_i32 s3, s3, 12288
    s_add_u32 s3, s3, 114688
    v_lshl_add_u32 v94, v0, 4, s3
    v_cmp_eq_u32 vcc, v3, v2
    v_mov_b32 v6, 0x3f80
    s_nop 0
    v_cndmask_b32 v6, 0, v6, vcc
    v_and_b32 v7, 1, v4
    v_lshlrev_b32 v7, 4, v7
    v_lshlrev_b32 v6, v7, v6
    v_cmp_gt_u32 vcc, 2, v4
    s_nop 1
    v_cndmask_b32 v5, 0, v6, vcc
    v_cndmask_b32 v7, v6, 0, vcc
    v_accvgpr_write_b32 a232, 0
    v_accvgpr_write_b32 a233, 0
    v_accvgpr_write_b32 a234, v5
    v_accvgpr_write_b32 a235, v7
    v_accvgpr_write_b32 a236, 0
    v_accvgpr_write_b32 a237, 0
    v_mov_b32 v112, 0
    v_mov_b32 v113, 0
    v_mov_b32 v114, 0
    v_mov_b32 v115, 0
    v_mov_b32 v116, 0
    v_mov_b32 v117, 0
    v_mov_b32 v118, 0
    v_mov_b32 v119, 0
    v_mov_b32 v120, 0
    v_mov_b32 v121, 0
    v_mov_b32 v122, 0
    v_mov_b32 v123, 0
    v_mov_b32 v124, 0
    v_mov_b32 v125, 0
    v_mov_b32 v126, 0
    v_mov_b32 v127, 0
    v_mov_b32 v128, 0
    v_mov_b32 v129, 0
    v_mov_b32 v130, 0
    v_mov_b32 v131, 0
    v_mov_b32 v132, 0
    v_mov_b32 v133, 0
    v_mov_b32 v134, 0
    v_mov_b32 v135, 0
    v_mov_b32 v136, 0
    v_mov_b32 v137, 0
    v_mov_b32 v138, 0
    v_mov_b32 v139, 0
    v_mov_b32 v140, 0
    v_mov_b32 v141, 0
    v_mov_b32 v142, 0
    v_mov_b32 v143, 0
    v_mov_b32 v144, 0
    v_mov_b32 v145, 0
    v_mov_b32 v146, 0
    v_mov_b32 v147, 0
    v_mov_b32 v148, 0
    v_mov_b32 v149, 0
    v_mov_b32 v150, 0
    v_mov_b32 v151, 0
    v_mov_b32 v152, 0
    v_mov_b32 v153, 0
    v_mov_b32 v154, 0
    v_mov_b32 v155, 0
    v_mov_b32 v156, 0
    v_mov_b32 v157, 0
    v_mov_b32 v158, 0
    v_mov_b32 v159, 0
    v_mov_b32 v160, 0
    v_mov_b32 v161, 0
    v_mov_b32 v162, 0
    v_mov_b32 v163, 0
    v_mov_b32 v164, 0
    v_mov_b32 v165, 0
    v_mov_b32 v166, 0
    v_mov_b32 v167, 0
    v_mov_b32 v168, 0
    v_mov_b32 v169, 0
    v_mov_b32 v170, 0
    v_mov_b32 v171, 0
    v_mov_b32 v172, 0
    v_mov_b32 v173, 0
    v_mov_b32 v174, 0
    v_mov_b32 v175, 0
    v_bfe_u32 v4, v0, 1, 1
    v_lshrrev_b32 v3, 5, v0
    v_cmp_eq_u32 vcc, v3, v4
    v_mov_b32 v3, 0x3f803f80
    v_and_b32 v4, 1, v0
    v_cndmask_b32 v3, 0, v3, vcc
    v_mul_u32_u24 v4, 0xaaaa, v4
    v_add_u32 v60, 0x4444, v4
    v_accvgpr_write_b32 a228, v3
    v_accvgpr_write_b32 a229, v3
    v_accvgpr_write_b32 a230, v3
    v_accvgpr_write_b32 a231, v3
    v_accvgpr_write_b32 a208, 0
    v_accvgpr_write_b32 a209, 0
    v_accvgpr_write_b32 a210, 0
    v_accvgpr_write_b32 a211, 0
    v_accvgpr_write_b32 a212, 0
    v_accvgpr_write_b32 a213, 0
    v_accvgpr_write_b32 a214, 0
    v_accvgpr_write_b32 a215, 0
    v_accvgpr_write_b32 a216, 0
    v_accvgpr_write_b32 a217, 0
    v_accvgpr_write_b32 a218, 0
    v_accvgpr_write_b32 a219, 0
    v_accvgpr_write_b32 a220, 0
    v_accvgpr_write_b32 a221, 0
    v_accvgpr_write_b32 a222, 0
    v_accvgpr_write_b32 a223, 0
    v_accvgpr_write_b32 a224, 0
    v_accvgpr_write_b32 a225, 0
    v_accvgpr_write_b32 a226, 0
    v_accvgpr_write_b32 a227, 0
    s_lshl_b32 s3, s26, 8
    s_add_u32 s38, s3, 61440
    v_lshl_add_u32 v7, v2, 4, s38
    v_lshlrev_b32 v6, 2, v0
    s_mov_b32 m0, s38
    s_nop 0
    buffer_load_dword v6, s[4:7], 0 offen lds
    s_lshl_b32 s58, s2, 7
    s_add_u32 s58, s58, 25165824
    s_lshl_b32 s3, s34, 6
    s_add_u32 s3, s3, s58
    v_lshl_add_u32 v3, v1, 2, s3
    v_mov_b32 v4, 0
    global_store_dword v3, v4, s[24:25] sc0 sc1
    s_lshl_b32 s60, s26, 2
    s_add_u32 s60, s60, 25165824
    s_lshl_b32 s61, s26, 10
    s_lshl_b32 s62, s26, 9
    s_add_u32 s62, s62, 3072
    s_mul_i32 s3, s35, 163840
    s_and_b32 s30, s2, 4
    s_lshl_b32 s30, s30, 8
    s_add_u32 s3, s3, s30
    s_lshl_b32 s30, s57, 6
    s_add_u32 s3, s3, s30
    s_lshl_b32 s63, s26, 15
    s_add_u32 s63, s63, s3
    s_lshl_b32 s32, s26, 3
    s_add_u32 s32, s32, s3
    s_add_u32 s32, s32, 131072
    s_mov_b32 s39, 0
    s_mov_b32 s38, 0x53800000
    s_add_u32 s36, s56, 4096
    s_mul_i32 s54, s34, 14
    s_mov_b32 s55, 0
    s_lshr_b32 s30, s26, 1
    s_lshl_b32 s32, s30, 15
    s_add_u32 s32, s32, s3
    s_and_b32 s3, s26, 1
    s_lshl4_add_u32 s32, s3, s32
    s_add_u32 s32, s32, 98304
    s_mul_i32 s59, s30, 0
    s_add_u32 s59, s59, 12584960
    s_cmp_eq_u32 s26, 3
    s_cselect_b32 s61, 25165824, s61
    s_xor_b32 s40, s2, 0
    s_mul_i32 s40, s40, 20480
    s_add_u32 s40, s40, 12582912
    s_xor_b32 s41, s2, 1
    s_mul_i32 s41, s41, 20480
    s_add_u32 s41, s41, 12588032
    s_xor_b32 s42, s2, 2
    s_mul_i32 s42, s42, 20480
    s_add_u32 s42, s42, 12593152
    s_xor_b32 s43, s2, 3
    s_mul_i32 s43, s43, 20480
    s_add_u32 s43, s43, 12598272
    s_add_u32 m0, s27, 114688
    s_nop 0
    buffer_load_dwordx4 v25, s[12:15], s99 offen offset:0 lds
    buffer_load_dwordx4 v26, s[12:15], s99 offen offset:1024 lds
    buffer_load_dwordx4 v27, s[12:15], s99 offen offset:2048 lds
    buffer_load_dwordx4 v28, s[12:15], s99 offen offset:3072 lds
    s_add_u32 s31, s31, 262144
    s_and_b32 s31, s31, 0x3fffff
    s_xor_b32 s99, s31, s98
    s_waitcnt vmcnt(6)
    s_barrier
    ds_read_b128 a[112:115], v8 offset:40960
    ds_read_b64_tr_b16 a[80:81], v16 offset:32768
    ds_read_b64_tr_b16 a[82:83], v16 offset:33280
    ds_read_b64_tr_b16 a[84:85], v16 offset:32776
    ds_read_b64_tr_b16 a[86:87], v16 offset:33288
    ds_read_b64_tr_b16 a[88:89], v17 offset:32768
    ds_read_b64_tr_b16 a[90:91], v17 offset:33280
    ds_read_b64_tr_b16 a[92:93], v17 offset:32776
    ds_read_b64_tr_b16 a[94:95], v17 offset:33288
    ds_read_b128 a[116:119], v8 offset:45056
    ds_read_b128 a[120:123], v8 offset:49152
    ds_read_b128 a[124:127], v8 offset:53248
    ds_read_b128 a[128:131], v8 offset:57344
    s_add_u32 m0, s27, 131072
    s_nop 0
    buffer_load_dwordx4 v25, s[12:15], s99 offen offset:0 lds
    buffer_load_dwordx4 v26, s[12:15], s99 offen offset:1024 lds
    buffer_load_dwordx4 v27, s[12:15], s99 offen offset:2048 lds
    buffer_load_dwordx4 v28, s[12:15], s99 offen offset:3072 lds
    s_add_u32 s31, s31, 262144
    s_and_b32 s31, s31, 0x3fffff
    s_xor_b32 s99, s31, s98
    s_waitcnt lgkmcnt(10)
    v_mfma_f32_16x16x32_bf16 v[176:179], a[80:83], a[112:115], 0
    s_waitcnt vmcnt(4)
    ds_read_b64_tr_b16 a[96:97], v16 offset:49152
    s_waitcnt lgkmcnt(9)
    v_mfma_f32_16x16x32_bf16 v[196:199], a[84:87], a[112:115], 0
    s_waitcnt lgkmcnt(5)
    s_add_u32 m0, s27, 147456
    ds_read_b64_tr_b16 a[98:99], v16 offset:49664
    v_mfma_f32_16x16x32_bf16 v[216:219], a[88:91], a[112:115], 0
    buffer_load_dwordx4 v25, s[12:15], s99 offen offset:0 lds
    v_mfma_f32_16x16x32_bf16 v[236:239], a[92:95], a[112:115], 0
    ds_read_b64_tr_b16 a[100:101], v16 offset:49160
    s_waitcnt lgkmcnt(6)
    v_mfma_f32_16x16x32_bf16 v[180:183], a[80:83], a[116:119], 0
    ds_read_b64_tr_b16 a[102:103], v16 offset:49672
    v_mfma_f32_16x16x32_bf16 v[200:203], a[84:87], a[116:119], 0
    buffer_load_dwordx4 v26, s[12:15], s99 offen offset:1024 lds
    v_mfma_f32_16x16x32_bf16 v[220:223], a[88:91], a[116:119], 0
    buffer_load_dwordx4 v27, s[12:15], s99 offen offset:2048 lds
    v_mfma_f32_16x16x32_bf16 v[240:243], a[92:95], a[116:119], 0
    ds_read_b128 a[132:135], v9 offset:40960
    s_waitcnt lgkmcnt(7)
    v_mfma_f32_16x16x32_bf16 v[184:187], a[80:83], a[120:123], 0
    ds_read_b64_tr_b16 a[104:105], v17 offset:49152
    v_mfma_f32_16x16x32_bf16 v[204:207], a[84:87], a[120:123], 0
    ds_read_b64_tr_b16 a[106:107], v17 offset:49664
    v_mfma_f32_16x16x32_bf16 v[224:227], a[88:91], a[120:123], 0
    buffer_load_dwordx4 v28, s[12:15], s99 offen offset:3072 lds
    v_mfma_f32_16x16x32_bf16 v[244:247], a[92:95], a[120:123], 0
    s_add_u32 s31, s31, 262144
    ds_read_b64_tr_b16 a[108:109], v17 offset:49160
    s_waitcnt lgkmcnt(9)
    v_mfma_f32_16x16x32_bf16 v[188:191], a[80:83], a[124:127], 0
    s_and_b32 s31, s31, 0x3fffff
    ds_read_b64_tr_b16 a[110:111], v17 offset:49672
    v_mfma_f32_16x16x32_bf16 v[208:211], a[84:87], a[124:127], 0
    s_xor_b32 s99, s31, s98
    s_add_u32 m0, s27, 65536
    ds_read_b128 a[136:139], v9 offset:45056
    v_mfma_f32_16x16x32_bf16 v[228:231], a[88:91], a[124:127], 0
    buffer_load_dwordx4 v25, s[12:15], s99 offen offset:0 lds
    v_mfma_f32_16x16x32_bf16 v[248:251], a[92:95], a[124:127], 0
    ds_read_b128 a[140:143], v9 offset:49152
    s_waitcnt lgkmcnt(11)
    v_mfma_f32_16x16x32_bf16 v[192:195], a[80:83], a[128:131], 0
    ds_read_b128 a[144:147], v9 offset:53248
    v_mfma_f32_16x16x32_bf16 v[212:215], a[84:87], a[128:131], 0
    ds_read_b128 a[148:151], v9 offset:57344
    v_mfma_f32_16x16x32_bf16 v[232:235], a[88:91], a[128:131], 0
    buffer_load_dwordx4 v26, s[12:15], s99 offen offset:1024 lds
    v_mfma_f32_16x16x32_bf16 v[252:255], a[92:95], a[128:131], 0
    buffer_load_dwordx4 v27, s[12:15], s99 offen offset:2048 lds
    s_waitcnt lgkmcnt(8)
    v_mfma_f32_16x16x32_bf16 v[176:179], a[96:99], a[132:135], v[176:179]
    s_waitcnt vmcnt(7)
    ds_read_b64_tr_b16 a[80:81], v18 offset:0
    v_mfma_f32_16x16x32_bf16 v[196:199], a[100:103], a[132:135], v[196:199]
    s_waitcnt lgkmcnt(5)
    ds_read_b64_tr_b16 a[82:83], v18 offset:512
    v_mfma_f32_16x16x32_bf16 v[216:219], a[104:107], a[132:135], v[216:219]
    buffer_load_dwordx4 v28, s[12:15], s99 offen offset:3072 lds
    v_mfma_f32_16x16x32_bf16 v[236:239], a[108:111], a[132:135], v[236:239]
    s_add_u32 s31, s31, 262144
    s_add_u32 m0, s96, 0
    ds_read_b64_tr_b16 a[84:85], v18 offset:8
    s_waitcnt lgkmcnt(6)
    v_mfma_f32_16x16x32_bf16 v[180:183], a[96:99], a[136:139], v[180:183]
    s_and_b32 s31, s31, 0x3fffff
    s_xor_b32 s99, s31, s98
    ds_read_b64_tr_b16 a[86:87], v18 offset:520
    v_mfma_f32_16x16x32_bf16 v[200:203], a[100:103], a[136:139], v[200:203]
    buffer_load_dwordx4 v20, s[16:19], s97 offen offset:0 lds
    v_mfma_f32_16x16x32_bf16 v[220:223], a[104:107], a[136:139], v[220:223]
    buffer_load_dwordx4 v21, s[16:19], s97 offen offset:1024 lds
    v_mfma_f32_16x16x32_bf16 v[240:243], a[108:111], a[136:139], v[240:243]
    ds_read_b128 a[112:115], v10 offset:40960
    s_waitcnt lgkmcnt(7)
    v_mfma_f32_16x16x32_bf16 v[184:187], a[96:99], a[140:143], v[184:187]
    ds_read_b64_tr_b16 a[88:89], v19 offset:0
    v_mfma_f32_16x16x32_bf16 v[204:207], a[100:103], a[140:143], v[204:207]
    ds_read_b64_tr_b16 a[90:91], v19 offset:512
    v_mfma_f32_16x16x32_bf16 v[224:227], a[104:107], a[140:143], v[224:227]
    buffer_load_dwordx4 v22, s[16:19], s97 offen offset:2048 lds
    v_mfma_f32_16x16x32_bf16 v[244:247], a[108:111], a[140:143], v[244:247]
    ds_read_b64_tr_b16 a[92:93], v19 offset:8
    s_waitcnt lgkmcnt(9)
    v_mfma_f32_16x16x32_bf16 v[188:191], a[96:99], a[144:147], v[188:191]
    ds_read_b64_tr_b16 a[94:95], v19 offset:520
    v_mfma_f32_16x16x32_bf16 v[208:211], a[100:103], a[144:147], v[208:211]
    ds_read_b128 a[116:119], v10 offset:45056
    v_mfma_f32_16x16x32_bf16 v[228:231], a[104:107], a[144:147], v[228:231]
    buffer_load_dwordx4 v23, s[16:19], s97 offen offset:3072 lds
    v_mfma_f32_16x16x32_bf16 v[248:251], a[108:111], a[144:147], v[248:251]
    ds_read_b128 a[120:123], v10 offset:49152
    s_waitcnt lgkmcnt(11)
    v_mfma_f32_16x16x32_bf16 v[192:195], a[96:99], a[148:151], v[192:195]
    ds_read_b128 a[124:127], v10 offset:53248
    v_mfma_f32_16x16x32_bf16 v[212:215], a[100:103], a[148:151], v[212:215]
    s_add_u32 m0, s96, 4096
    ds_read_b128 a[128:131], v10 offset:57344
    v_mfma_f32_16x16x32_bf16 v[232:235], a[104:107], a[148:151], v[232:235]
    buffer_load_dwordx4 v24, s[16:19], s97 offen offset:0 lds
    v_mfma_f32_16x16x32_bf16 v[252:255], a[108:111], a[148:151], v[252:255]
    s_add_u32 s97, s97, 256
    s_and_b32 s97, s97, 0x3ff
    s_add_u32 m0, s27, 81920
    s_nop 0
    buffer_load_dwordx4 v25, s[12:15], s99 offen offset:0 lds
    s_waitcnt lgkmcnt(8)
    v_mfma_f32_16x16x32_bf16 v[176:179], a[80:83], a[112:115], v[176:179]
    s_waitcnt vmcnt(10)
    ds_read_b64_tr_b16 a[96:97], v18 offset:16384
    v_mfma_f32_16x16x32_bf16 v[196:199], a[84:87], a[112:115], v[196:199]
    s_waitcnt lgkmcnt(5)
    ds_read_b64_tr_b16 a[98:99], v18 offset:16896
    v_mfma_f32_16x16x32_bf16 v[216:219], a[88:91], a[112:115], v[216:219]
    buffer_load_dwordx4 v26, s[12:15], s99 offen offset:1024 lds
    v_mfma_f32_16x16x32_bf16 v[236:239], a[92:95], a[112:115], v[236:239]
    ds_read_b64_tr_b16 a[100:101], v18 offset:16392
    s_waitcnt lgkmcnt(6)
    v_mfma_f32_16x16x32_bf16 v[180:183], a[80:83], a[116:119], v[180:183]
    ds_read_b64_tr_b16 a[102:103], v18 offset:16904
    v_mfma_f32_16x16x32_bf16 v[200:203], a[84:87], a[116:119], v[200:203]
    buffer_load_dwordx4 v27, s[12:15], s99 offen offset:2048 lds
    v_mfma_f32_16x16x32_bf16 v[220:223], a[88:91], a[116:119], v[220:223]
    buffer_load_dwordx4 v28, s[12:15], s99 offen offset:3072 lds
    v_mfma_f32_16x16x32_bf16 v[240:243], a[92:95], a[116:119], v[240:243]
    s_add_u32 s31, s31, 262144
    ds_read_b128 a[132:135], v11 offset:40960
    s_waitcnt lgkmcnt(7)
    v_mfma_f32_16x16x32_bf16 v[184:187], a[80:83], a[120:123], v[184:187]
    s_and_b32 s31, s31, 0x3fffff
    ds_read_b64_tr_b16 a[104:105], v19 offset:16384
    v_mfma_f32_16x16x32_bf16 v[204:207], a[84:87], a[120:123], v[204:207]
    s_xor_b32 s99, s31, s98
    s_add_u32 m0, s27, 98304
    ds_read_b64_tr_b16 a[106:107], v19 offset:16896
    v_mfma_f32_16x16x32_bf16 v[224:227], a[88:91], a[120:123], v[224:227]
    buffer_load_dwordx4 v25, s[12:15], s99 offen offset:0 lds
    v_mfma_f32_16x16x32_bf16 v[244:247], a[92:95], a[120:123], v[244:247]
    ds_read_b64_tr_b16 a[108:109], v19 offset:16392
    s_waitcnt lgkmcnt(9)
    v_mfma_f32_16x16x32_bf16 v[188:191], a[80:83], a[124:127], v[188:191]
    ds_read_b64_tr_b16 a[110:111], v19 offset:16904
    v_mfma_f32_16x16x32_bf16 v[208:211], a[84:87], a[124:127], v[208:211]
    ds_read_b128 a[136:139], v11 offset:45056
    v_mfma_f32_16x16x32_bf16 v[228:231], a[88:91], a[124:127], v[228:231]
    buffer_load_dwordx4 v26, s[12:15], s99 offen offset:1024 lds
    v_mfma_f32_16x16x32_bf16 v[248:251], a[92:95], a[124:127], v[248:251]
    ds_read_b128 a[140:143], v11 offset:49152
    s_waitcnt lgkmcnt(11)
    v_mfma_f32_16x16x32_bf16 v[192:195], a[80:83], a[128:131], v[192:195]
    ds_read_b128 a[144:147], v11 offset:53248
    v_mfma_f32_16x16x32_bf16 v[212:215], a[84:87], a[128:131], v[212:215]
    ds_read_b128 a[148:151], v11 offset:57344
    v_mfma_f32_16x16x32_bf16 v[232:235], a[88:91], a[128:131], v[232:235]
    buffer_load_dwordx4 v27, s[12:15], s99 offen offset:2048 lds
    v_mfma_f32_16x16x32_bf16 v[252:255], a[92:95], a[128:131], v[252:255]
    buffer_load_dwordx4 v28, s[12:15], s99 offen offset:3072 lds
    s_waitcnt lgkmcnt(8)
    v_mfma_f32_16x16x32_bf16 v[176:179], a[96:99], a[132:135], v[176:179]
    s_waitcnt vmcnt(13)
    s_add_u32 s31, s31, 262144
    s_add_u32 m0, s27, 114688
    ds_read_b64_tr_b16 a[80:81], v16 offset:0
    v_mfma_f32_16x16x32_bf16 v[196:199], a[100:103], a[132:135], v[196:199]
    s_waitcnt lgkmcnt(5)
    s_and_b32 s31, s31, 0x3fffff
    s_xor_b32 s99, s31, s98
    ds_read_b64_tr_b16 a[82:83], v16 offset:512
    v_mfma_f32_16x16x32_bf16 v[216:219], a[104:107], a[132:135], v[216:219]
    buffer_load_dwordx4 v25, s[12:15], s99 offen offset:0 lds
    v_mfma_f32_16x16x32_bf16 v[236:239], a[108:111], a[132:135], v[236:239]
    s_waitcnt lgkmcnt(2)
    ds_read_b64_tr_b16 a[84:85], v16 offset:8
    v_mfma_f32_16x16x32_bf16 v[180:183], a[96:99], a[136:139], v[180:183]
    s_waitcnt vmcnt(9)
    ds_read_b64_tr_b16 a[86:87], v16 offset:520
    v_mfma_f32_16x16x32_bf16 v[200:203], a[100:103], a[136:139], v[200:203]
    s_barrier
    v_mfma_f32_16x16x32_bf16 v[220:223], a[104:107], a[136:139], v[220:223]
    buffer_load_dwordx4 v26, s[12:15], s99 offen offset:1024 lds
    v_mfma_f32_16x16x32_bf16 v[240:243], a[108:111], a[136:139], v[240:243]
    ds_read_b128 a[112:115], v8 offset:0
    v_mfma_f32_16x16x32_bf16 v[184:187], a[96:99], a[140:143], v[184:187]
    ds_read_b64_tr_b16 a[88:89], v17 offset:0
    v_mfma_f32_16x16x32_bf16 v[204:207], a[100:103], a[140:143], v[204:207]
    ds_read_b64_tr_b16 a[90:91], v17 offset:512
    v_mfma_f32_16x16x32_bf16 v[224:227], a[104:107], a[140:143], v[224:227]
    buffer_load_dwordx4 v27, s[12:15], s99 offen offset:2048 lds
    v_mfma_f32_16x16x32_bf16 v[244:247], a[108:111], a[140:143], v[244:247]
    ds_read_b64_tr_b16 a[92:93], v17 offset:8
    v_mfma_f32_16x16x32_bf16 v[188:191], a[96:99], a[144:147], v[188:191]
    ds_read_b64_tr_b16 a[94:95], v17 offset:520
    v_mfma_f32_16x16x32_bf16 v[208:211], a[100:103], a[144:147], v[208:211]
    ds_read_b128 a[116:119], v8 offset:4096
    v_mfma_f32_16x16x32_bf16 v[228:231], a[104:107], a[144:147], v[228:231]
    buffer_load_dwordx4 v28, s[12:15], s99 offen offset:3072 lds
    v_mfma_f32_16x16x32_bf16 v[248:251], a[108:111], a[144:147], v[248:251]
    s_add_u32 s31, s31, 262144
    ds_read_b128 a[120:123], v8 offset:8192
    v_mfma_f32_16x16x32_bf16 v[192:195], a[96:99], a[148:151], v[192:195]
    s_and_b32 s31, s31, 0x3fffff
    ds_read_b128 a[124:127], v8 offset:12288
    v_mfma_f32_16x16x32_bf16 v[212:215], a[100:103], a[148:151], v[212:215]
    s_xor_b32 s99, s31, s98
    s_add_u32 m0, s27, 131072
    ds_read_b128 a[128:131], v8 offset:16384
    v_mfma_f32_16x16x32_bf16 v[232:235], a[104:107], a[148:151], v[232:235]
    buffer_load_dwordx4 v25, s[12:15], s99 offen offset:0 lds
    v_mfma_f32_16x16x32_bf16 v[252:255], a[108:111], a[148:151], v[252:255]
    buffer_load_dwordx4 v26, s[12:15], s99 offen offset:1024 lds
    s_waitcnt lgkmcnt(8)
    v_mfma_f32_16x16x32_bf16 v[176:179], a[80:83], a[112:115], v[176:179]
    s_waitcnt vmcnt(10)
    ds_read_b64_tr_b16 a[96:97], v16 offset:16384
    v_mfma_f32_16x16x32_bf16 v[196:199], a[84:87], a[112:115], v[196:199]
    s_waitcnt lgkmcnt(5)
    ds_read_b64_tr_b16 a[98:99], v16 offset:16896
    v_mfma_f32_16x16x32_bf16 v[216:219], a[88:91], a[112:115], v[216:219]
    buffer_load_dwordx4 v27, s[12:15], s99 offen offset:2048 lds
    v_mfma_f32_16x16x32_bf16 v[236:239], a[92:95], a[112:115], v[236:239]
    ds_read_b64_tr_b16 a[100:101], v16 offset:16392
    s_waitcnt lgkmcnt(6)
    v_mfma_f32_16x16x32_bf16 v[180:183], a[80:83], a[116:119], v[180:183]
    ds_read_b64_tr_b16 a[102:103], v16 offset:16904
    v_mfma_f32_16x16x32_bf16 v[200:203], a[84:87], a[116:119], v[200:203]
    buffer_load_dwordx4 v28, s[12:15], s99 offen offset:3072 lds
    v_mfma_f32_16x16x32_bf16 v[220:223], a[88:91], a[116:119], v[220:223]
    s_add_u32 s31, s31, 262144
    s_and_b32 s31, s31, 0x3fffff
    s_xor_b32 s99, s31, s98
    s_add_u32 m0, s96, 20480
    s_nop 0
    buffer_load_dwordx4 v20, s[16:19], s97 offen offset:0 lds
    v_mfma_f32_16x16x32_bf16 v[240:243], a[92:95], a[116:119], v[240:243]
    ds_read_b128 a[132:135], v9 offset:0
    s_waitcnt lgkmcnt(7)
    v_mfma_f32_16x16x32_bf16 v[184:187], a[80:83], a[120:123], v[184:187]
    ds_read_b64_tr_b16 a[104:105], v17 offset:16384
    v_mfma_f32_16x16x32_bf16 v[204:207], a[84:87], a[120:123], v[204:207]
    ds_read_b64_tr_b16 a[106:107], v17 offset:16896
    v_mfma_f32_16x16x32_bf16 v[224:227], a[88:91], a[120:123], v[224:227]
    buffer_load_dwordx4 v21, s[16:19], s97 offen offset:1024 lds
    v_mfma_f32_16x16x32_bf16 v[244:247], a[92:95], a[120:123], v[244:247]
    ds_read_b64_tr_b16 a[108:109], v17 offset:16392
    s_waitcnt lgkmcnt(9)
    v_mfma_f32_16x16x32_bf16 v[188:191], a[80:83], a[124:127], v[188:191]
    ds_read_b64_tr_b16 a[110:111], v17 offset:16904
    v_mfma_f32_16x16x32_bf16 v[208:211], a[84:87], a[124:127], v[208:211]
    ds_read_b128 a[136:139], v9 offset:4096
    v_mfma_f32_16x16x32_bf16 v[228:231], a[88:91], a[124:127], v[228:231]
    buffer_load_dwordx4 v22, s[16:19], s97 offen offset:2048 lds
    v_mfma_f32_16x16x32_bf16 v[248:251], a[92:95], a[124:127], v[248:251]
    ds_read_b128 a[140:143], v9 offset:8192
    s_waitcnt lgkmcnt(11)
    v_mfma_f32_16x16x32_bf16 v[192:195], a[80:83], a[128:131], v[192:195]
    ds_read_b128 a[144:147], v9 offset:12288
    v_mfma_f32_16x16x32_bf16 v[212:215], a[84:87], a[128:131], v[212:215]
    ds_read_b128 a[148:151], v9 offset:16384
    v_mfma_f32_16x16x32_bf16 v[232:235], a[88:91], a[128:131], v[232:235]
    buffer_load_dwordx4 v23, s[16:19], s97 offen offset:3072 lds
    v_mfma_f32_16x16x32_bf16 v[252:255], a[92:95], a[128:131], v[252:255]
    s_add_u32 m0, s96, 24576
    s_nop 0
    buffer_load_dwordx4 v24, s[16:19], s97 offen offset:0 lds
    s_waitcnt lgkmcnt(8)
    v_mfma_f32_16x16x32_bf16 v[176:179], a[96:99], a[132:135], v[176:179]
    s_waitcnt vmcnt(13)
    s_add_u32 s97, s97, 256
    ds_read_b64_tr_b16 a[80:81], v16 offset:32768
    v_mfma_f32_16x16x32_bf16 v[196:199], a[100:103], a[132:135], v[196:199]
    s_waitcnt lgkmcnt(5)
    s_and_b32 s97, s97, 0x3ff
    s_add_u32 m0, s27, 147456
    ds_read_b64_tr_b16 a[82:83], v16 offset:33280
    v_mfma_f32_16x16x32_bf16 v[216:219], a[104:107], a[132:135], v[216:219]
    buffer_load_dwordx4 v25, s[12:15], s99 offen offset:0 lds
    v_mfma_f32_16x16x32_bf16 v[236:239], a[108:111], a[132:135], v[236:239]
    ds_read_b64_tr_b16 a[84:85], v16 offset:32776
    s_waitcnt lgkmcnt(6)
    v_mfma_f32_16x16x32_bf16 v[180:183], a[96:99], a[136:139], v[180:183]
    ds_read_b64_tr_b16 a[86:87], v16 offset:33288
    v_mfma_f32_16x16x32_bf16 v[200:203], a[100:103], a[136:139], v[200:203]
    buffer_load_dwordx4 v26, s[12:15], s99 offen offset:1024 lds
    v_mfma_f32_16x16x32_bf16 v[220:223], a[104:107], a[136:139], v[220:223]
    buffer_load_dwordx4 v27, s[12:15], s99 offen offset:2048 lds
    v_mfma_f32_16x16x32_bf16 v[240:243], a[108:111], a[136:139], v[240:243]
    ds_read_b128 a[112:115], v10 offset:0
    s_waitcnt lgkmcnt(7)
    v_mfma_f32_16x16x32_bf16 v[184:187], a[96:99], a[140:143], v[184:187]
    ds_read_b64_tr_b16 a[88:89], v17 offset:32768
    v_mfma_f32_16x16x32_bf16 v[204:207], a[100:103], a[140:143], v[204:207]
    ds_read_b64_tr_b16 a[90:91], v17 offset:33280
    v_mfma_f32_16x16x32_bf16 v[224:227], a[104:107], a[140:143], v[224:227]
    buffer_load_dwordx4 v28, s[12:15], s99 offen offset:3072 lds
    v_mfma_f32_16x16x32_bf16 v[244:247], a[108:111], a[140:143], v[244:247]
    s_add_u32 s31, s31, 262144
    ds_read_b64_tr_b16 a[92:93], v17 offset:32776
    s_waitcnt lgkmcnt(9)
    v_mfma_f32_16x16x32_bf16 v[188:191], a[96:99], a[144:147], v[188:191]
    s_and_b32 s31, s31, 0x3fffff
    ds_read_b64_tr_b16 a[94:95], v17 offset:33288
    v_mfma_f32_16x16x32_bf16 v[208:211], a[100:103], a[144:147], v[208:211]
    s_xor_b32 s99, s31, s98
    s_add_u32 m0, s27, 65536
    ds_read_b128 a[116:119], v10 offset:4096
    v_mfma_f32_16x16x32_bf16 v[228:231], a[104:107], a[144:147], v[228:231]
    buffer_load_dwordx4 v25, s[12:15], s99 offen offset:0 lds
    v_mfma_f32_16x16x32_bf16 v[248:251], a[108:111], a[144:147], v[248:251]
    ds_read_b128 a[120:123], v10 offset:8192
    s_waitcnt lgkmcnt(11)
    v_mfma_f32_16x16x32_bf16 v[192:195], a[96:99], a[148:151], v[192:195]
    ds_read_b128 a[124:127], v10 offset:12288
    v_mfma_f32_16x16x32_bf16 v[212:215], a[100:103], a[148:151], v[212:215]
    ds_read_b128 a[128:131], v10 offset:16384
    v_mfma_f32_16x16x32_bf16 v[232:235], a[104:107], a[148:151], v[232:235]
    buffer_load_dwordx4 v26, s[12:15], s99 offen offset:1024 lds
    v_mfma_f32_16x16x32_bf16 v[252:255], a[108:111], a[148:151], v[252:255]
    buffer_load_dwordx4 v27, s[12:15], s99 offen offset:2048 lds
    s_waitcnt lgkmcnt(8)
    v_mfma_f32_16x16x32_bf16 v[176:179], a[80:83], a[112:115], v[176:179]
    s_waitcnt vmcnt(16)
    ds_read_b64_tr_b16 a[96:97], v16 offset:49152
    v_mfma_f32_16x16x32_bf16 v[196:199], a[84:87], a[112:115], v[196:199]
    s_waitcnt lgkmcnt(5)
    ds_read_b64_tr_b16 a[98:99], v16 offset:49664
    v_mfma_f32_16x16x32_bf16 v[216:219], a[88:91], a[112:115], v[216:219]
    buffer_load_dwordx4 v28, s[12:15], s99 offen offset:3072 lds
    v_mfma_f32_16x16x32_bf16 v[236:239], a[92:95], a[112:115], v[236:239]
    s_add_u32 s31, s31, 262144
    s_add_u32 m0, s27, 81920
    ds_read_b64_tr_b16 a[100:101], v16 offset:49160
    s_waitcnt lgkmcnt(6)
    v_mfma_f32_16x16x32_bf16 v[180:183], a[80:83], a[116:119], v[180:183]
    s_and_b32 s31, s31, 0x3fffff
    s_xor_b32 s99, s31, s98
    ds_read_b64_tr_b16 a[102:103], v16 offset:49672
    v_mfma_f32_16x16x32_bf16 v[200:203], a[84:87], a[116:119], v[200:203]
    buffer_load_dwordx4 v25, s[12:15], s99 offen offset:0 lds
    v_mfma_f32_16x16x32_bf16 v[220:223], a[88:91], a[116:119], v[220:223]
    buffer_load_dwordx4 v26, s[12:15], s99 offen offset:1024 lds
    v_mfma_f32_16x16x32_bf16 v[240:243], a[92:95], a[116:119], v[240:243]
    ds_read_b128 a[132:135], v11 offset:0
    s_waitcnt lgkmcnt(7)
    v_mfma_f32_16x16x32_bf16 v[184:187], a[80:83], a[120:123], v[184:187]
    ds_read_b64_tr_b16 a[104:105], v17 offset:49152
    v_mfma_f32_16x16x32_bf16 v[204:207], a[84:87], a[120:123], v[204:207]
    ds_read_b64_tr_b16 a[106:107], v17 offset:49664
    v_mfma_f32_16x16x32_bf16 v[224:227], a[88:91], a[120:123], v[224:227]
    buffer_load_dwordx4 v27, s[12:15], s99 offen offset:2048 lds
    v_mfma_f32_16x16x32_bf16 v[244:247], a[92:95], a[120:123], v[244:247]
    ds_read_b64_tr_b16 a[108:109], v17 offset:49160
    s_waitcnt lgkmcnt(9)
    v_mfma_f32_16x16x32_bf16 v[188:191], a[80:83], a[124:127], v[188:191]
    ds_read_b64_tr_b16 a[110:111], v17 offset:49672
    v_mfma_f32_16x16x32_bf16 v[208:211], a[84:87], a[124:127], v[208:211]
    ds_read_b128 a[136:139], v11 offset:4096
    v_mfma_f32_16x16x32_bf16 v[228:231], a[88:91], a[124:127], v[228:231]
    buffer_load_dwordx4 v28, s[12:15], s99 offen offset:3072 lds
    v_mfma_f32_16x16x32_bf16 v[248:251], a[92:95], a[124:127], v[248:251]
    s_add_u32 s31, s31, 262144
    ds_read_b128 a[140:143], v11 offset:8192
    s_waitcnt lgkmcnt(11)
    v_mfma_f32_16x16x32_bf16 v[192:195], a[80:83], a[128:131], v[192:195]
    s_and_b32 s31, s31, 0x3fffff
    ds_read_b128 a[144:147], v11 offset:12288
    v_mfma_f32_16x16x32_bf16 v[212:215], a[84:87], a[128:131], v[212:215]
    s_xor_b32 s99, s31, s98
    s_add_u32 m0, s27, 98304
    ds_read_b128 a[148:151], v11 offset:16384
    v_mfma_f32_16x16x32_bf16 v[232:235], a[88:91], a[128:131], v[232:235]
    buffer_load_dwordx4 v25, s[12:15], s99 offen offset:0 lds
    v_mfma_f32_16x16x32_bf16 v[252:255], a[92:95], a[128:131], v[252:255]
    buffer_load_dwordx4 v26, s[12:15], s99 offen offset:1024 lds
    s_waitcnt lgkmcnt(8)
    v_mfma_f32_16x16x32_bf16 v[176:179], a[96:99], a[132:135], v[176:179]
    s_waitcnt vmcnt(19)
    ds_read_b64_tr_b16 a[80:81], v18 offset:0
    v_mfma_f32_16x16x32_bf16 v[196:199], a[100:103], a[132:135], v[196:199]
    s_waitcnt lgkmcnt(5)
    ds_read_b64_tr_b16 a[82:83], v18 offset:512
    v_mfma_f32_16x16x32_bf16 v[216:219], a[104:107], a[132:135], v[216:219]
    buffer_load_dwordx4 v27, s[12:15], s99 offen offset:2048 lds
    v_mfma_f32_16x16x32_bf16 v[236:239], a[108:111], a[132:135], v[236:239]
    s_waitcnt lgkmcnt(2)
    ds_read_b64_tr_b16 a[84:85], v18 offset:8
    v_mfma_f32_16x16x32_bf16 v[180:183], a[96:99], a[136:139], v[180:183]
    s_waitcnt vmcnt(15)
    ds_read_b64_tr_b16 a[86:87], v18 offset:520
    v_mfma_f32_16x16x32_bf16 v[200:203], a[100:103], a[136:139], v[200:203]
    s_barrier
    v_mfma_f32_16x16x32_bf16 v[220:223], a[104:107], a[136:139], v[220:223]
    buffer_load_dwordx4 v28, s[12:15], s99 offen offset:3072 lds
    v_mfma_f32_16x16x32_bf16 v[240:243], a[108:111], a[136:139], v[240:243]
    s_add_u32 s31, s31, 262144
    ds_read_b128 a[112:115], v8 offset:20480
    v_mfma_f32_16x16x32_bf16 v[184:187], a[96:99], a[140:143], v[184:187]
    s_and_b32 s31, s31, 0x3fffff
    ds_read_b64_tr_b16 a[88:89], v19 offset:0
    v_mfma_f32_16x16x32_bf16 v[204:207], a[100:103], a[140:143], v[204:207]
    s_xor_b32 s99, s31, s98
    s_add_u32 m0, s96, 40960
    ds_read_b64_tr_b16 a[90:91], v19 offset:512
    v_mfma_f32_16x16x32_bf16 v[224:227], a[104:107], a[140:143], v[224:227]
    buffer_load_dwordx4 v20, s[16:19], s97 offen offset:0 lds
    v_mfma_f32_16x16x32_bf16 v[244:247], a[108:111], a[140:143], v[244:247]
    ds_read_b64_tr_b16 a[92:93], v19 offset:8
    v_mfma_f32_16x16x32_bf16 v[188:191], a[96:99], a[144:147], v[188:191]
    ds_read_b64_tr_b16 a[94:95], v19 offset:520
    v_mfma_f32_16x16x32_bf16 v[208:211], a[100:103], a[144:147], v[208:211]
    ds_read_b128 a[116:119], v8 offset:24576
    v_mfma_f32_16x16x32_bf16 v[228:231], a[104:107], a[144:147], v[228:231]
    buffer_load_dwordx4 v21, s[16:19], s97 offen offset:1024 lds
    v_mfma_f32_16x16x32_bf16 v[248:251], a[108:111], a[144:147], v[248:251]
    ds_read_b128 a[120:123], v8 offset:28672
    v_mfma_f32_16x16x32_bf16 v[192:195], a[96:99], a[148:151], v[192:195]
    ds_read_b128 a[124:127], v8 offset:32768
    v_mfma_f32_16x16x32_bf16 v[212:215], a[100:103], a[148:151], v[212:215]
    ds_read_b128 a[128:131], v8 offset:36864
    v_mfma_f32_16x16x32_bf16 v[232:235], a[104:107], a[148:151], v[232:235]
    buffer_load_dwordx4 v22, s[16:19], s97 offen offset:2048 lds
    v_mfma_f32_16x16x32_bf16 v[252:255], a[108:111], a[148:151], v[252:255]
    buffer_load_dwordx4 v23, s[16:19], s97 offen offset:3072 lds
    s_waitcnt lgkmcnt(8)
    v_mfma_f32_16x16x32_bf16 v[176:179], a[80:83], a[112:115], v[176:179]
    s_waitcnt vmcnt(16)
    ds_read_b64_tr_b16 a[96:97], v18 offset:16384
    v_mfma_f32_16x16x32_bf16 v[196:199], a[84:87], a[112:115], v[196:199]
    s_waitcnt lgkmcnt(5)
    s_add_u32 m0, s96, 45056
    ds_read_b64_tr_b16 a[98:99], v18 offset:16896
    v_mfma_f32_16x16x32_bf16 v[216:219], a[88:91], a[112:115], v[216:219]
    buffer_load_dwordx4 v24, s[16:19], s97 offen offset:0 lds
    v_mfma_f32_16x16x32_bf16 v[236:239], a[92:95], a[112:115], v[236:239]
    ds_read_b64_tr_b16 a[100:101], v18 offset:16392
    s_waitcnt lgkmcnt(6)
    v_mfma_f32_16x16x32_bf16 v[180:183], a[80:83], a[116:119], v[180:183]
    ds_read_b64_tr_b16 a[102:103], v18 offset:16904
    v_mfma_f32_16x16x32_bf16 v[200:203], a[84:87], a[116:119], v[200:203]
    s_add_u32 m0, s27, 114688
    ds_read_b128 v[96:99], v7 offset:0
    v_mfma_f32_16x16x32_bf16 v[220:223], a[88:91], a[116:119], v[220:223]
    buffer_load_dwordx4 v25, s[12:15], s99 offen offset:0 lds
    v_mfma_f32_16x16x32_bf16 v[240:243], a[92:95], a[116:119], v[240:243]
    ds_read_b128 a[132:135], v9 offset:20480
    s_waitcnt lgkmcnt(8)
    v_mfma_f32_16x16x32_bf16 v[184:187], a[80:83], a[120:123], v[184:187]
    ds_read_b64_tr_b16 a[104:105], v19 offset:16384
    v_mfma_f32_16x16x32_bf16 v[204:207], a[84:87], a[120:123], v[204:207]
    ds_read_b64_tr_b16 a[106:107], v19 offset:16896
    v_mfma_f32_16x16x32_bf16 v[224:227], a[88:91], a[120:123], v[224:227]
    buffer_load_dwordx4 v26, s[12:15], s99 offen offset:1024 lds
    v_mfma_f32_16x16x32_bf16 v[244:247], a[92:95], a[120:123], v[244:247]
    ds_read_b64_tr_b16 a[108:109], v19 offset:16392
    s_waitcnt lgkmcnt(10)
    v_mfma_f32_16x16x32_bf16 v[188:191], a[80:83], a[124:127], v[188:191]
    ds_read_b64_tr_b16 a[110:111], v19 offset:16904
    v_mfma_f32_16x16x32_bf16 v[208:211], a[84:87], a[124:127], v[208:211]
    ds_read_b128 a[136:139], v9 offset:24576
    v_mfma_f32_16x16x32_bf16 v[228:231], a[88:91], a[124:127], v[228:231]
    buffer_load_dwordx4 v27, s[12:15], s99 offen offset:2048 lds
    v_mfma_f32_16x16x32_bf16 v[248:251], a[92:95], a[124:127], v[248:251]
    ds_read_b128 a[140:143], v9 offset:28672
    s_waitcnt lgkmcnt(12)
    v_mfma_f32_16x16x32_bf16 v[192:195], a[80:83], a[128:131], v[192:195]
    ds_read_b128 a[144:147], v9 offset:32768
    v_mfma_f32_16x16x32_bf16 v[212:215], a[84:87], a[128:131], v[212:215]
    ds_read_b128 a[148:151], v9 offset:36864
    v_mfma_f32_16x16x32_bf16 v[232:235], a[88:91], a[128:131], v[232:235]
    buffer_load_dwordx4 v28, s[12:15], s99 offen offset:3072 lds
    v_mfma_f32_16x16x32_bf16 v[252:255], a[92:95], a[128:131], v[252:255]
    s_add_u32 s31, s31, 262144
    s_add_u32 m0, s27, 131072
    ds_read_b128 v[100:103], v7 offset:64
    s_waitcnt lgkmcnt(9)
    v_mfma_f32_16x16x32_bf16 v[176:179], a[96:99], a[132:135], v[176:179]
    s_waitcnt vmcnt(17)
    s_and_b32 s31, s31, 0x3fffff
    ds_read_b64_tr_b16 a[80:81], v16 offset:0
    v_mfma_f32_16x16x32_bf16 v[196:199], a[100:103], a[132:135], v[196:199]
    s_waitcnt lgkmcnt(6)
    s_xor_b32 s99, s31, s98
    ds_read_b64_tr_b16 a[82:83], v16 offset:512
    v_mfma_f32_16x16x32_bf16 v[216:219], a[104:107], a[132:135], v[216:219]
    buffer_load_dwordx4 v25, s[12:15], s99 offen offset:0 lds
    v_mfma_f32_16x16x32_bf16 v[236:239], a[108:111], a[132:135], v[236:239]
    ds_read_b64_tr_b16 a[84:85], v16 offset:8
    s_waitcnt lgkmcnt(7)
    v_mfma_f32_16x16x32_bf16 v[180:183], a[96:99], a[136:139], v[180:183]
    ds_read_b64_tr_b16 a[86:87], v16 offset:520
    v_mfma_f32_16x16x32_bf16 v[200:203], a[100:103], a[136:139], v[200:203]
    ds_read_b128 v[104:107], v7 offset:128
    v_mfma_f32_16x16x32_bf16 v[220:223], a[104:107], a[136:139], v[220:223]
    buffer_load_dwordx4 v26, s[12:15], s99 offen offset:1024 lds
    v_mfma_f32_16x16x32_bf16 v[240:243], a[108:111], a[136:139], v[240:243]
    ds_read_b128 a[112:115], v10 offset:20480
    s_waitcnt lgkmcnt(9)
    v_mfma_f32_16x16x32_bf16 v[184:187], a[96:99], a[140:143], v[184:187]
    ds_read_b64_tr_b16 a[88:89], v17 offset:0
    v_mfma_f32_16x16x32_bf16 v[204:207], a[100:103], a[140:143], v[204:207]
    ds_read_b64_tr_b16 a[90:91], v17 offset:512
    v_mfma_f32_16x16x32_bf16 v[224:227], a[104:107], a[140:143], v[224:227]
    buffer_load_dwordx4 v27, s[12:15], s99 offen offset:2048 lds
    v_mfma_f32_16x16x32_bf16 v[244:247], a[108:111], a[140:143], v[244:247]
    ds_read_b64_tr_b16 a[92:93], v17 offset:8
    s_waitcnt lgkmcnt(11)
    v_mfma_f32_16x16x32_bf16 v[188:191], a[96:99], a[144:147], v[188:191]
    ds_read_b64_tr_b16 a[94:95], v17 offset:520
    v_mfma_f32_16x16x32_bf16 v[208:211], a[100:103], a[144:147], v[208:211]
    ds_read_b128 a[116:119], v10 offset:24576
    v_mfma_f32_16x16x32_bf16 v[228:231], a[104:107], a[144:147], v[228:231]
    buffer_load_dwordx4 v28, s[12:15], s99 offen offset:3072 lds
    v_mfma_f32_16x16x32_bf16 v[248:251], a[108:111], a[144:147], v[248:251]
    s_add_u32 s31, s31, 262144
    ds_read_b128 a[120:123], v10 offset:28672
    s_waitcnt lgkmcnt(13)
    v_mfma_f32_16x16x32_bf16 v[192:195], a[96:99], a[148:151], v[192:195]
    s_and_b32 s31, s31, 0x3fffff
    ds_read_b128 a[124:127], v10 offset:32768
    v_mfma_f32_16x16x32_bf16 v[212:215], a[100:103], a[148:151], v[212:215]
    s_xor_b32 s99, s31, s98
    s_add_u32 m0, s27, 147456
    ds_read_b128 a[128:131], v10 offset:36864
    v_mfma_f32_16x16x32_bf16 v[232:235], a[104:107], a[148:151], v[232:235]
    buffer_load_dwordx4 v25, s[12:15], s99 offen offset:0 lds
    v_mfma_f32_16x16x32_bf16 v[252:255], a[108:111], a[148:151], v[252:255]
    ds_read_b128 v[108:111], v7 offset:192
    s_waitcnt lgkmcnt(9)
    v_mfma_f32_16x16x32_bf16 v[176:179], a[80:83], a[112:115], v[176:179]
    s_waitcnt vmcnt(18)
    ds_read_b64_tr_b16 a[96:97], v16 offset:16384
    v_mfma_f32_16x16x32_bf16 v[196:199], a[84:87], a[112:115], v[196:199]
    s_waitcnt lgkmcnt(6)
    ds_read_b64_tr_b16 a[98:99], v16 offset:16896
    v_mfma_f32_16x16x32_bf16 v[216:219], a[88:91], a[112:115], v[216:219]
    buffer_load_dwordx4 v26, s[12:15], s99 offen offset:1024 lds
    v_mfma_f32_16x16x32_bf16 v[236:239], a[92:95], a[112:115], v[236:239]
    ds_read_b64_tr_b16 a[100:101], v16 offset:16392
    s_waitcnt lgkmcnt(7)
    v_mfma_f32_16x16x32_bf16 v[180:183], a[80:83], a[116:119], v[180:183]
    ds_read_b64_tr_b16 a[102:103], v16 offset:16904
    v_mfma_f32_16x16x32_bf16 v[200:203], a[84:87], a[116:119], v[200:203]
    buffer_load_dwordx4 v27, s[12:15], s99 offen offset:2048 lds
    v_mfma_f32_16x16x32_bf16 v[220:223], a[88:91], a[116:119], v[220:223]
    buffer_load_dwordx4 v28, s[12:15], s99 offen offset:3072 lds
    v_mfma_f32_16x16x32_bf16 v[240:243], a[92:95], a[116:119], v[240:243]
    ds_read_b128 a[132:135], v11 offset:20480
    s_waitcnt lgkmcnt(8)
    v_mfma_f32_16x16x32_bf16 v[184:187], a[80:83], a[120:123], v[184:187]
    s_add_u32 m0, s27, 0
    ds_read_b64_tr_b16 a[104:105], v17 offset:16384
    v_mfma_f32_16x16x32_bf16 v[204:207], a[84:87], a[120:123], v[204:207]
    s_mov_b32 s28, 0
    ds_read_b64_tr_b16 a[106:107], v17 offset:16896
    v_mfma_f32_16x16x32_bf16 v[224:227], a[88:91], a[120:123], v[224:227]
    buffer_load_dwordx4 v76, s[4:7], s28 offen offset:0 nt lds
    v_mfma_f32_16x16x32_bf16 v[244:247], a[92:95], a[120:123], v[244:247]
    ds_read_b64_tr_b16 a[108:109], v17 offset:16392
    s_waitcnt lgkmcnt(10)
    v_mfma_f32_16x16x32_bf16 v[188:191], a[80:83], a[124:127], v[188:191]
    ds_read_b64_tr_b16 a[110:111], v17 offset:16904
    v_mfma_f32_16x16x32_bf16 v[208:211], a[84:87], a[124:127], v[208:211]
    ds_read_b128 a[136:139], v11 offset:24576
    v_mfma_f32_16x16x32_bf16 v[228:231], a[88:91], a[124:127], v[228:231]
    buffer_load_dwordx4 v77, s[4:7], s28 offen offset:1024 nt lds
    v_mfma_f32_16x16x32_bf16 v[248:251], a[92:95], a[124:127], v[248:251]
    ds_read_b128 a[140:143], v11 offset:28672
    s_waitcnt lgkmcnt(12)
    v_mfma_f32_16x16x32_bf16 v[192:195], a[80:83], a[128:131], v[192:195]
    ds_read_b128 a[144:147], v11 offset:32768
    v_mfma_f32_16x16x32_bf16 v[212:215], a[84:87], a[128:131], v[212:215]
    ds_read_b128 a[148:151], v11 offset:36864
    v_mfma_f32_16x16x32_bf16 v[232:235], a[88:91], a[128:131], v[232:235]
    buffer_load_dwordx4 v78, s[4:7], s28 offen offset:2048 nt lds
    v_mfma_f32_16x16x32_bf16 v[252:255], a[92:95], a[128:131], v[252:255]
    buffer_load_dwordx4 v79, s[4:7], s28 offen offset:3072 nt lds
    s_waitcnt lgkmcnt(8)
    v_mfma_f32_16x16x32_bf16 v[176:179], a[96:99], a[132:135], v[176:179]
    s_waitcnt vmcnt(21)
    ds_read_b64_tr_b16 a[80:81], v16 offset:32768
    v_mfma_f32_16x16x32_bf16 v[196:199], a[100:103], a[132:135], v[196:199]
    s_waitcnt lgkmcnt(5)
    s_add_u32 m0, s27, 65536
    ds_read_b64_tr_b16 a[82:83], v16 offset:33280
    v_mfma_f32_16x16x32_bf16 v[216:219], a[104:107], a[132:135], v[216:219]
    buffer_load_dwordx4 v80, s[8:11], s28 offen offset:0 nt lds
    v_mfma_f32_16x16x32_bf16 v[236:239], a[108:111], a[132:135], v[236:239]
    s_waitcnt lgkmcnt(2)
    ds_read_b64_tr_b16 a[84:85], v16 offset:32776
    v_mfma_f32_16x16x32_bf16 v[180:183], a[96:99], a[136:139], v[180:183]
    s_waitcnt vmcnt(17)
    ds_read_b64_tr_b16 a[86:87], v16 offset:33288
    v_mfma_f32_16x16x32_bf16 v[200:203], a[100:103], a[136:139], v[200:203]
    s_barrier
    v_mfma_f32_16x16x32_bf16 v[220:223], a[104:107], a[136:139], v[220:223]
    buffer_load_dwordx4 v81, s[8:11], s28 offen offset:1024 nt lds
    v_mfma_f32_16x16x32_bf16 v[240:243], a[108:111], a[136:139], v[240:243]
    ds_read_b128 a[112:115], v8 offset:40960
    v_mfma_f32_16x16x32_bf16 v[184:187], a[96:99], a[140:143], v[184:187]
    ds_read_b64_tr_b16 a[88:89], v17 offset:32768
    v_mfma_f32_16x16x32_bf16 v[204:207], a[100:103], a[140:143], v[204:207]
    ds_read_b64_tr_b16 a[90:91], v17 offset:33280
    v_mfma_f32_16x16x32_bf16 v[224:227], a[104:107], a[140:143], v[224:227]
    buffer_load_dwordx4 v80, s[8:11], s28 offen offset:2048 nt lds
    v_mfma_f32_16x16x32_bf16 v[244:247], a[108:111], a[140:143], v[244:247]
    ds_read_b64_tr_b16 a[92:93], v17 offset:32776
    v_mfma_f32_16x16x32_bf16 v[188:191], a[96:99], a[144:147], v[188:191]
    ds_read_b64_tr_b16 a[94:95], v17 offset:33288
    v_mfma_f32_16x16x32_bf16 v[208:211], a[100:103], a[144:147], v[208:211]
    ds_read_b128 a[116:119], v8 offset:45056
    v_mfma_f32_16x16x32_bf16 v[228:231], a[104:107], a[144:147], v[228:231]
    buffer_load_dwordx4 v81, s[8:11], s28 offen offset:3072 nt lds
    v_mfma_f32_16x16x32_bf16 v[248:251], a[108:111], a[144:147], v[248:251]
    ds_read_b128 a[120:123], v8 offset:49152
    v_mfma_f32_16x16x32_bf16 v[192:195], a[96:99], a[148:151], v[192:195]
    s_add_u32 m0, s27, 16384
    ds_read_b128 a[124:127], v8 offset:53248
    v_mfma_f32_16x16x32_bf16 v[212:215], a[100:103], a[148:151], v[212:215]
    s_mov_b32 s28, 16384
    ds_read_b128 a[128:131], v8 offset:57344
    v_mfma_f32_16x16x32_bf16 v[232:235], a[104:107], a[148:151], v[232:235]
    buffer_load_dwordx4 v76, s[4:7], s28 offen offset:0 nt lds
    v_mfma_f32_16x16x32_bf16 v[252:255], a[108:111], a[148:151], v[252:255]
    s_waitcnt lgkmcnt(8)
    v_mfma_f32_16x16x32_bf16 v[176:179], a[80:83], a[112:115], v[176:179]
    s_waitcnt vmcnt(17)
    ds_read_b64_tr_b16 a[96:97], v16 offset:49152
    v_xor_b32 v96, 0x80008000, v96
    v_mfma_f32_16x16x32_bf16 v[196:199], a[84:87], a[112:115], v[196:199]
    s_waitcnt lgkmcnt(5)
    ds_read_b64_tr_b16 a[98:99], v16 offset:49664
    v_mfma_f32_16x16x32_bf16 v[216:219], a[88:91], a[112:115], v[216:219]
    buffer_load_dwordx4 v77, s[4:7], s28 offen offset:1024 nt lds
    v_mfma_f32_16x16x32_bf16 v[236:239], a[92:95], a[112:115], v[236:239]
    ds_read_b64_tr_b16 a[100:101], v16 offset:49160
    v_xor_b32 v97, 0x80008000, v97
    s_waitcnt lgkmcnt(6)
    v_mfma_f32_16x16x32_bf16 v[180:183], a[80:83], a[116:119], v[180:183]
    ds_read_b64_tr_b16 a[102:103], v16 offset:49672
    v_mfma_f32_16x16x32_bf16 v[200:203], a[84:87], a[116:119], v[200:203]
    v_xor_b32 v98, 0x80008000, v98
    v_mfma_f32_16x16x32_bf16 v[220:223], a[88:91], a[116:119], v[220:223]
    buffer_load_dwordx4 v78, s[4:7], s28 offen offset:2048 nt lds
    v_mfma_f32_16x16x32_bf16 v[240:243], a[92:95], a[116:119], v[240:243]
    ds_read_b128 a[132:135], v9 offset:40960
    v_xor_b32 v99, 0x80008000, v99
    s_waitcnt lgkmcnt(7)
    v_mfma_f32_16x16x32_bf16 v[184:187], a[80:83], a[120:123], v[184:187]
    ds_read_b64_tr_b16 a[104:105], v17 offset:49152
    v_mfma_f32_16x16x32_bf16 v[204:207], a[84:87], a[120:123], v[204:207]
    ds_read_b64_tr_b16 a[106:107], v17 offset:49664
    v_xor_b32 v100, 0x80008000, v100
    v_mfma_f32_16x16x32_bf16 v[224:227], a[88:91], a[120:123], v[224:227]
    buffer_load_dwordx4 v79, s[4:7], s28 offen offset:3072 nt lds
    v_mfma_f32_16x16x32_bf16 v[244:247], a[92:95], a[120:123], v[244:247]
    ds_read_b64_tr_b16 a[108:109], v17 offset:49160
    s_waitcnt lgkmcnt(9)
    v_mfma_f32_16x16x32_bf16 v[188:191], a[80:83], a[124:127], v[188:191]
    ds_read_b64_tr_b16 a[110:111], v17 offset:49672
    v_xor_b32 v101, 0x80008000, v101
    v_mfma_f32_16x16x32_bf16 v[208:211], a[84:87], a[124:127], v[208:211]
    ds_read_b128 a[136:139], v9 offset:45056
    v_mfma_f32_16x16x32_bf16 v[228:231], a[88:91], a[124:127], v[228:231]
    v_mfma_f32_16x16x32_bf16 v[248:251], a[92:95], a[124:127], v[248:251]
    ds_read_b128 a[140:143], v9 offset:49152
    s_waitcnt lgkmcnt(11)
    v_mfma_f32_16x16x32_bf16 v[192:195], a[80:83], a[128:131], v[192:195]
    ds_read_b128 a[144:147], v9 offset:53248
    v_xor_b32 v102, 0x80008000, v102
    v_mfma_f32_16x16x32_bf16 v[212:215], a[84:87], a[128:131], v[212:215]
    ds_read_b128 a[148:151], v9 offset:57344
    v_mfma_f32_16x16x32_bf16 v[232:235], a[88:91], a[128:131], v[232:235]
    v_mfma_f32_16x16x32_bf16 v[252:255], a[92:95], a[128:131], v[252:255]
    v_xor_b32 v103, 0x80008000, v103
    s_waitcnt lgkmcnt(8)
    v_mfma_f32_16x16x32_bf16 v[176:179], a[96:99], a[132:135], v[176:179]
    s_waitcnt vmcnt(16)
    ds_read_b64_tr_b16 a[80:81], v18 offset:0
    v_xor_b32 v104, 0x80008000, v104
    v_mfma_f32_16x16x32_bf16 v[196:199], a[100:103], a[132:135], v[196:199]
    s_waitcnt lgkmcnt(5)
    ds_read_b64_tr_b16 a[82:83], v18 offset:512
    v_mfma_f32_16x16x32_bf16 v[216:219], a[104:107], a[132:135], v[216:219]
    v_mfma_f32_16x16x32_bf16 v[236:239], a[108:111], a[132:135], v[236:239]
    ds_read_b64_tr_b16 a[84:85], v18 offset:8
    v_xor_b32 v105, 0x80008000, v105
    s_waitcnt lgkmcnt(6)
    v_mfma_f32_16x16x32_bf16 v[180:183], a[96:99], a[136:139], v[180:183]
    ds_read_b64_tr_b16 a[86:87], v18 offset:520
    v_mfma_f32_16x16x32_bf16 v[200:203], a[100:103], a[136:139], v[200:203]
    v_xor_b32 v106, 0x80008000, v106
    v_mfma_f32_16x16x32_bf16 v[220:223], a[104:107], a[136:139], v[220:223]
    v_mfma_f32_16x16x32_bf16 v[240:243], a[108:111], a[136:139], v[240:243]
    ds_read_b128 a[112:115], v10 offset:40960
    v_xor_b32 v107, 0x80008000, v107
    s_waitcnt lgkmcnt(7)
    v_mfma_f32_16x16x32_bf16 v[184:187], a[96:99], a[140:143], v[184:187]
    ds_read_b64_tr_b16 a[88:89], v19 offset:0
    v_mfma_f32_16x16x32_bf16 v[204:207], a[100:103], a[140:143], v[204:207]
    ds_read_b64_tr_b16 a[90:91], v19 offset:512
    v_xor_b32 v108, 0x80008000, v108
    v_mfma_f32_16x16x32_bf16 v[224:227], a[104:107], a[140:143], v[224:227]
    v_mfma_f32_16x16x32_bf16 v[244:247], a[108:111], a[140:143], v[244:247]
    ds_read_b64_tr_b16 a[92:93], v19 offset:8
    s_waitcnt lgkmcnt(9)
    v_mfma_f32_16x16x32_bf16 v[188:191], a[96:99], a[144:147], v[188:191]
    ds_read_b64_tr_b16 a[94:95], v19 offset:520
    v_xor_b32 v109, 0x80008000, v109
    v_mfma_f32_16x16x32_bf16 v[208:211], a[100:103], a[144:147], v[208:211]
    ds_read_b128 a[116:119], v10 offset:45056
    v_mfma_f32_16x16x32_bf16 v[228:231], a[104:107], a[144:147], v[228:231]
    v_mfma_f32_16x16x32_bf16 v[248:251], a[108:111], a[144:147], v[248:251]
    ds_read_b128 a[120:123], v10 offset:49152
    s_waitcnt lgkmcnt(11)
    v_mfma_f32_16x16x32_bf16 v[192:195], a[96:99], a[148:151], v[192:195]
    ds_read_b128 a[124:127], v10 offset:53248
    v_xor_b32 v110, 0x80008000, v110
    v_mfma_f32_16x16x32_bf16 v[212:215], a[100:103], a[148:151], v[212:215]
    ds_read_b128 a[128:131], v10 offset:57344
    v_mfma_f32_16x16x32_bf16 v[232:235], a[104:107], a[148:151], v[232:235]
    v_mfma_f32_16x16x32_bf16 v[252:255], a[108:111], a[148:151], v[252:255]
    v_xor_b32 v111, 0x80008000, v111
    s_mov_b32 s3, 0x3e0293ee
    s_waitcnt lgkmcnt(8)
    v_mfma_f32_16x16x32_bf16 v[176:179], a[80:83], a[112:115], v[176:179]
    s_waitcnt vmcnt(12)
    ds_read_b128 a[132:135], v11 offset:40960
    ds_read_b64_tr_b16 a[96:97], v18 offset:16384
    v_mfma_f32_16x16x32_bf16 v[196:199], a[84:87], a[112:115], v[196:199]
    ds_read_b64_tr_b16 a[98:99], v18 offset:16896
    ds_read_b64_tr_b16 a[100:101], v18 offset:16392
    s_waitcnt lgkmcnt(10)
    v_mfma_f32_16x16x32_bf16 v[216:219], a[88:91], a[112:115], v[216:219]
    ds_read_b64_tr_b16 a[102:103], v18 offset:16904
    ds_read_b64_tr_b16 a[104:105], v19 offset:16384
    s_waitcnt lgkmcnt(10)
    v_mfma_f32_16x16x32_bf16 v[236:239], a[92:95], a[112:115], v[236:239]
    ds_read_b64_tr_b16 a[106:107], v19 offset:16896
    ds_read_b64_tr_b16 a[108:109], v19 offset:16392
    ds_read_b64_tr_b16 a[110:111], v19 offset:16904
    s_waitcnt lgkmcnt(12)
    v_mfma_f32_16x16x32_bf16 v[180:183], a[80:83], a[116:119], v[180:183]
    ds_read_b128 a[136:139], v11 offset:45056
    ds_read_b128 a[140:143], v11 offset:49152
    v_mfma_f32_16x16x32_bf16 v[200:203], a[84:87], a[116:119], v[200:203]
    ds_read_b128 a[144:147], v11 offset:53248
    ds_read_b128 a[148:151], v11 offset:57344
    v_mfma_f32_16x16x32_bf16 v[220:223], a[88:91], a[116:119], v[220:223]
    s_add_u32 m0, s27, 81920
    v_mfma_f32_16x16x32_bf16 v[240:243], a[92:95], a[116:119], v[240:243]
    buffer_load_dwordx4 v80, s[8:11], s28 offen offset:0 nt lds
    s_waitcnt lgkmcnt(10)
    v_mfma_f32_16x16x32_bf16 v[176:179], a[96:99], a[132:135], v[176:179]
    buffer_load_dwordx4 v81, s[8:11], s28 offen offset:1024 nt lds
    s_waitcnt lgkmcnt(8)
    v_mfma_f32_16x16x32_bf16 v[196:199], a[100:103], a[132:135], v[196:199]
    buffer_load_dwordx4 v80, s[8:11], s28 offen offset:2048 nt lds
    s_waitcnt lgkmcnt(6)
    v_mfma_f32_16x16x32_bf16 v[216:219], a[104:107], a[132:135], v[216:219]
    buffer_load_dwordx4 v81, s[8:11], s28 offen offset:3072 nt lds
    s_waitcnt lgkmcnt(4)
    v_mfma_f32_16x16x32_bf16 v[236:239], a[108:111], a[132:135], v[236:239]
    s_mov_b32 s28, 32768
    v_mfma_f32_16x16x32_bf16 v[184:187], a[80:83], a[120:123], v[184:187]
    s_waitcnt vmcnt(12)
    s_waitcnt lgkmcnt(0)
    s_barrier
    v_mfma_f32_16x16x32_bf16 v[204:207], a[84:87], a[120:123], v[204:207]
    s_add_u32 m0, s27, 98304
    v_mul_f32 v176, s3, v176
    v_mul_f32 v177, s3, v177
    v_mul_f32 v178, s3, v178
    v_mfma_f32_16x16x32_bf16 v[224:227], a[88:91], a[120:123], v[224:227]
    buffer_load_dwordx4 v80, s[8:11], s28 offen offset:0 nt lds
    v_mul_f32 v179, s3, v179
    v_mul_f32 v196, s3, v196
    v_mul_f32 v197, s3, v197
    v_mfma_f32_16x16x32_bf16 v[244:247], a[92:95], a[120:123], v[244:247]
    buffer_load_dwordx4 v81, s[8:11], s28 offen offset:1024 nt lds
    v_mul_f32 v198, s3, v198
    v_mul_f32 v199, s3, v199
    v_cvt_pk_bf16_f32 v176, v176, v177
    v_mfma_f32_16x16x32_bf16 v[180:183], a[96:99], a[136:139], v[180:183]
    buffer_load_dwordx4 v80, s[8:11], s28 offen offset:2048 nt lds
    v_cvt_pk_bf16_f32 v177, v178, v179
    v_cvt_pk_bf16_f32 v178, v196, v197
    v_cvt_pk_bf16_f32 v179, v198, v199
    v_mfma_f32_16x16x32_bf16 v[200:203], a[100:103], a[136:139], v[200:203]
    buffer_load_dwordx4 v81, s[8:11], s28 offen offset:3072 nt lds
    ds_write_b128 v90, v[176:179] offset:0
    v_mul_f32 v216, s3, v216
    v_mfma_f32_16x16x32_bf16 v[220:223], a[104:107], a[136:139], v[220:223]
    v_mul_f32 v217, s3, v217
    v_mul_f32 v218, s3, v218
    v_mul_f32 v219, s3, v219
    v_mul_f32 v236, s3, v236
    v_mfma_f32_16x16x32_bf16 v[240:243], a[108:111], a[136:139], v[240:243]
    v_mul_f32 v237, s3, v237
    v_mul_f32 v238, s3, v238
    v_mul_f32 v239, s3, v239
    v_cvt_pk_bf16_f32 v216, v216, v217
    v_mfma_f32_16x16x32_bf16 v[188:191], a[80:83], a[124:127], v[188:191]
    v_cvt_pk_bf16_f32 v217, v218, v219
    v_cvt_pk_bf16_f32 v218, v236, v237
    v_cvt_pk_bf16_f32 v219, v238, v239
    ds_write_b128 v90, v[216:219] offset:5120
    v_mfma_f32_16x16x32_bf16 v[208:211], a[84:87], a[124:127], v[208:211]
    v_mul_f32 v180, s3, v180
    v_mul_f32 v181, s3, v181
    v_mul_f32 v182, s3, v182
    v_mfma_f32_16x16x32_bf16 v[228:231], a[88:91], a[124:127], v[228:231]
    v_mul_f32 v183, s3, v183
    v_mul_f32 v200, s3, v200
    v_mul_f32 v201, s3, v201
    v_mul_f32 v202, s3, v202
    v_mfma_f32_16x16x32_bf16 v[248:251], a[92:95], a[124:127], v[248:251]
    v_mul_f32 v203, s3, v203
    v_cvt_pk_bf16_f32 v180, v180, v181
    v_cvt_pk_bf16_f32 v181, v182, v183
    v_mfma_f32_16x16x32_bf16 v[184:187], a[96:99], a[140:143], v[184:187]
    v_cvt_pk_bf16_f32 v182, v200, v201
    v_cvt_pk_bf16_f32 v183, v202, v203
    ds_write_b128 v90, v[180:183] offset:1024
    v_mul_f32 v220, s3, v220
    v_mfma_f32_16x16x32_bf16 v[204:207], a[100:103], a[140:143], v[204:207]
    v_mul_f32 v221, s3, v221
    v_mul_f32 v222, s3, v222
    v_mul_f32 v223, s3, v223
    v_mfma_f32_16x16x32_bf16 v[224:227], a[104:107], a[140:143], v[224:227]
    v_mul_f32 v240, s3, v240
    v_mul_f32 v241, s3, v241
    v_mul_f32 v242, s3, v242
    v_mfma_f32_16x16x32_bf16 v[244:247], a[108:111], a[140:143], v[244:247]
    v_mul_f32 v243, s3, v243
    v_cvt_pk_bf16_f32 v220, v220, v221
    v_cvt_pk_bf16_f32 v221, v222, v223
    v_cvt_pk_bf16_f32 v222, v240, v241
    v_mfma_f32_16x16x32_bf16 v[192:195], a[80:83], a[128:131], v[192:195]
    s_mov_b32 s28, 32768
    v_cvt_pk_bf16_f32 v223, v242, v243
    ds_write_b128 v90, v[220:223] offset:6144
    v_mfma_f32_16x16x32_bf16 v[212:215], a[84:87], a[128:131], v[212:215]
    v_mul_f32 v184, s3, v184
    v_mul_f32 v185, s3, v185
    v_mul_f32 v186, s3, v186
    v_mul_f32 v187, s3, v187
    v_mfma_f32_16x16x32_bf16 v[232:235], a[88:91], a[128:131], v[232:235]
    s_add_u32 m0, s27, 32768
    v_mul_f32 v204, s3, v204
    v_mul_f32 v205, s3, v205
    v_mul_f32 v206, s3, v206
    v_mfma_f32_16x16x32_bf16 v[252:255], a[92:95], a[128:131], v[252:255]
    v_mul_f32 v207, s3, v207
    v_cvt_pk_bf16_f32 v184, v184, v185
    v_cvt_pk_bf16_f32 v185, v186, v187
    v_mfma_f32_16x16x32_bf16 v[188:191], a[96:99], a[144:147], v[188:191]
    buffer_load_dwordx4 v76, s[4:7], s28 offen offset:0 nt lds
    v_cvt_pk_bf16_f32 v186, v204, v205
    v_cvt_pk_bf16_f32 v187, v206, v207
    ds_write_b128 v90, v[184:187] offset:2048
    v_mfma_f32_16x16x32_bf16 v[208:211], a[100:103], a[144:147], v[208:211]
    v_mul_f32 v224, s3, v224
    v_mul_f32 v225, s3, v225
    v_mul_f32 v226, s3, v226
    v_mul_f32 v227, s3, v227
    v_mfma_f32_16x16x32_bf16 v[228:231], a[104:107], a[144:147], v[228:231]
    buffer_load_dwordx4 v77, s[4:7], s28 offen offset:1024 nt lds
    v_mul_f32 v244, s3, v244
    v_mul_f32 v245, s3, v245
    v_mul_f32 v246, s3, v246
    v_mfma_f32_16x16x32_bf16 v[248:251], a[108:111], a[144:147], v[248:251]
    v_mul_f32 v247, s3, v247
    v_cvt_pk_bf16_f32 v224, v224, v225
    v_cvt_pk_bf16_f32 v225, v226, v227
    v_mfma_f32_16x16x32_bf16 v[192:195], a[96:99], a[148:151], v[192:195]
    buffer_load_dwordx4 v78, s[4:7], s28 offen offset:2048 nt lds
    v_cvt_pk_bf16_f32 v226, v244, v245
    v_cvt_pk_bf16_f32 v227, v246, v247
    ds_write_b128 v90, v[224:227] offset:7168
    v_mfma_f32_16x16x32_bf16 v[212:215], a[100:103], a[148:151], v[212:215]
    v_mul_f32 v188, s3, v188
    v_mul_f32 v189, s3, v189
    v_mul_f32 v190, s3, v190
    v_mul_f32 v191, s3, v191
    v_mul_f32 v208, s3, v208
    v_mul_f32 v209, s3, v209
    v_mul_f32 v210, s3, v210
    v_mfma_f32_16x16x32_bf16 v[232:235], a[104:107], a[148:151], v[232:235]
    buffer_load_dwordx4 v79, s[4:7], s28 offen offset:3072 nt lds
    v_mul_f32 v211, s3, v211
    v_cvt_pk_bf16_f32 v188, v188, v189
    v_cvt_pk_bf16_f32 v189, v190, v191
    v_cvt_pk_bf16_f32 v190, v208, v209
    v_cvt_pk_bf16_f32 v191, v210, v211
    ds_write_b128 v90, v[188:191] offset:3072
    v_mfma_f32_16x16x32_bf16 v[252:255], a[108:111], a[148:151], v[252:255]
    v_mul_f32 v228, s3, v228
    v_mul_f32 v229, s3, v229
    v_mul_f32 v230, s3, v230
    v_mul_f32 v231, s3, v231
    v_mul_f32 v248, s3, v248
    v_mul_f32 v249, s3, v249
    v_mul_f32 v250, s3, v250
    v_mul_f32 v251, s3, v251
    v_cvt_pk_bf16_f32 v228, v228, v229
    v_cvt_pk_bf16_f32 v229, v230, v231
    v_cvt_pk_bf16_f32 v230, v248, v249
    v_cvt_pk_bf16_f32 v231, v250, v251
    ds_write_b128 v90, v[228:231] offset:8192
    v_mul_f32 v192, s3, v192
    v_mul_f32 v193, s3, v193
    v_mul_f32 v194, s3, v194
    v_mul_f32 v195, s3, v195
    v_mul_f32 v212, s3, v212
    v_mul_f32 v213, s3, v213
    v_mul_f32 v214, s3, v214
    v_mul_f32 v215, s3, v215
    v_cvt_pk_bf16_f32 v192, v192, v193
    v_cvt_pk_bf16_f32 v193, v194, v195
    v_cvt_pk_bf16_f32 v194, v212, v213
    v_cvt_pk_bf16_f32 v195, v214, v215
    ds_write_b128 v90, v[192:195] offset:4096
    v_mul_f32 v232, s3, v232
    v_mul_f32 v233, s3, v233
    v_mul_f32 v234, s3, v234
    v_mul_f32 v235, s3, v235
    v_mul_f32 v252, s3, v252
    v_mul_f32 v253, s3, v253
    v_mul_f32 v254, s3, v254
    v_mul_f32 v255, s3, v255
    v_cvt_pk_bf16_f32 v232, v232, v233
    v_cvt_pk_bf16_f32 v233, v234, v235
    v_cvt_pk_bf16_f32 v234, v252, v253
    v_cvt_pk_bf16_f32 v235, v254, v255
    ds_write_b128 v90, v[232:235] offset:9216
    ds_read_b128 a[80:83], v64 offset:0
    ds_read_b128 a[84:87], v65 offset:0
    ds_read_b128 a[88:91], v66 offset:0
    ds_read_b128 a[92:95], v67 offset:0
    ds_read_b128 a[96:99], v64 offset:4096
    ds_read_b128 a[100:103], v65 offset:4096
    ds_read_b128 a[104:107], v66 offset:4096
    ds_read_b128 a[108:111], v67 offset:4096
    v_mov_b32 v196, 0
    v_mov_b32 v197, 0
    v_mov_b32 v198, 0
    v_mov_b32 v199, 0
    v_mov_b32 v236, 0
    v_mov_b32 v237, 0
    v_mov_b32 v238, 0
    v_mov_b32 v239, 0
    v_mov_b32 v176, 0
    v_mov_b32 v177, 0
    v_mov_b32 v178, 0
    v_mov_b32 v179, 0
    v_mov_b32 v216, 0
    v_mov_b32 v217, 0
    v_mov_b32 v218, 0
    v_mov_b32 v219, 0
    v_mov_b32 v200, 0
    v_mov_b32 v201, 0
    v_mov_b32 v202, 0
    v_mov_b32 v203, 0
    v_mov_b32 v240, 0
    v_mov_b32 v241, 0
    v_mov_b32 v242, 0
    v_mov_b32 v243, 0
    s_waitcnt vmcnt(16)
    s_waitcnt lgkmcnt(0)
    s_barrier
    ds_read_b128 a[0:3], v94 offset:0
    ds_read_b128 a[4:7], v94 offset:5120
    ds_read_b128 a[8:11], v94 offset:12288
    ds_read_b128 a[12:15], v94 offset:17408
    ds_read_b128 a[16:19], v94 offset:1024
    ds_read_b128 a[20:23], v94 offset:6144
    ds_read_b128 a[24:27], v94 offset:13312
    ds_read_b128 a[28:31], v94 offset:18432
    ds_read_b128 a[32:35], v94 offset:2048
    ds_read_b128 a[36:39], v94 offset:7168
    ds_read_b128 a[40:43], v94 offset:14336
    ds_read_b128 a[44:47], v94 offset:19456
    ds_read_b128 a[48:51], v94 offset:3072
    ds_read_b128 a[52:55], v94 offset:8192
    ds_read_b128 a[56:59], v94 offset:15360
    ds_read_b128 a[60:63], v94 offset:20480
    ds_read_b128 a[64:67], v94 offset:4096
    ds_read_b128 a[68:71], v94 offset:9216
    ds_read_b128 a[72:75], v94 offset:16384
    ds_read_b128 a[76:79], v94 offset:21504
    s_cmp_lg_u32 s34, 0
    s_cbranch_scc1 L_fb2
    v_mov_b32 v180, 0
    v_mov_b32 v181, 0
    v_mov_b32 v182, 0
    v_mov_b32 v183, 0
    v_mov_b32 v220, 0
    v_mov_b32 v221, 0
    v_mov_b32 v222, 0
    v_mov_b32 v223, 0
    v_mov_b32 v204, 0
    v_mov_b32 v205, 0
    v_mov_b32 v206, 0
    v_mov_b32 v207, 0
    v_mov_b32 v244, 0
    v_mov_b32 v245, 0
    v_mov_b32 v246, 0
    v_mov_b32 v247, 0
    v_mov_b32 v184, 0
    v_mov_b32 v185, 0
    v_mov_b32 v186, 0
    v_mov_b32 v187, 0
    s_waitcnt lgkmcnt(15)
    v_mfma_f32_16x16x32_bf16 v[32:35], v[96:99], a[0:3], 0
    v_mov_b32 v224, 0
    v_mov_b32 v225, 0
    v_mfma_f32_16x16x32_bf16 v[32:35], v[100:103], a[4:7], v[32:35]
    v_mov_b32 v226, 0
    v_mov_b32 v227, 0
    v_mov_b32 v208, 0
    v_mfma_f32_16x16x32_bf16 v[32:35], v[104:107], a[8:11], v[32:35]
    v_mov_b32 v209, 0
    v_mov_b32 v210, 0
    v_mfma_f32_16x16x32_bf16 v[32:35], v[108:111], a[12:15], v[32:35]
    v_mov_b32 v211, 0
    v_mov_b32 v248, 0
    v_mfma_f32_16x16x32_bf16 v[36:39], v[96:99], a[16:19], 0
    ds_read_b64_tr_b16 a[144:145], v68 offset:0
    v_mov_b32 v249, 0
    v_mov_b32 v250, 0
    s_waitcnt lgkmcnt(15)
    v_mfma_f32_16x16x32_bf16 v[36:39], v[100:103], a[20:23], v[36:39]
    v_mov_b32 v251, 0
    v_mov_b32 v188, 0
    v_mov_b32 v189, 0
    s_waitcnt lgkmcnt(14)
    v_mfma_f32_16x16x32_bf16 v[36:39], v[104:107], a[24:27], v[36:39]
    v_mov_b32 v190, 0
    v_mov_b32 v191, 0
    s_waitcnt lgkmcnt(13)
    v_mfma_f32_16x16x32_bf16 v[36:39], v[108:111], a[28:31], v[36:39]
    ds_read_b64_tr_b16 a[146:147], v68 offset:4096
    v_mov_b32 v228, 0
    v_mov_b32 v229, 0
    v_mfma_f32_16x16x32_bf16 v[8:11], a[80:83], a[0:3], v[32:35]
    v_mov_b32 v230, 0
    v_mov_b32 v231, 0
    v_mfma_f32_16x16x32_bf16 v[8:11], a[84:87], a[4:7], v[8:11]
    v_mov_b32 v212, 0
    v_mov_b32 v213, 0
    v_mov_b32 v214, 0
    v_mfma_f32_16x16x32_bf16 v[8:11], a[88:91], a[8:11], v[8:11]
    ds_read_b64_tr_b16 a[148:149], v69 offset:0
    v_mov_b32 v215, 0
    v_mov_b32 v252, 0
    v_mfma_f32_16x16x32_bf16 v[8:11], a[92:95], a[12:15], v[8:11]
    ds_read_b64_tr_b16 a[150:151], v69 offset:4096
    v_mov_b32 v253, 0
    v_mov_b32 v254, 0
    v_mfma_f32_16x16x32_bf16 v[12:15], a[96:99], a[0:3], v[32:35]
    v_mov_b32 v255, 0
    v_mov_b32 v192, 0
    v_mfma_f32_16x16x32_bf16 v[12:15], a[100:103], a[4:7], v[12:15]
    v_mov_b32 v193, 0
    v_mov_b32 v194, 0
    v_mov_b32 v195, 0
    v_mfma_f32_16x16x32_bf16 v[12:15], a[104:107], a[8:11], v[12:15]
    ds_read_b64_tr_b16 a[152:153], v70 offset:0
    s_waitcnt lgkmcnt(5)
    s_barrier
    v_mov_b32 v232, 0
    v_mov_b32 v233, 0
    v_mfma_f32_16x16x32_bf16 v[12:15], a[108:111], a[12:15], v[12:15]
    s_mov_b32 s28, 49152
    v_mov_b32 v234, 0
    v_mov_b32 v235, 0
    v_mfma_f32_16x16x32_bf16 v[40:43], v[96:99], a[32:35], 0
    ds_read_b64_tr_b16 a[154:155], v70 offset:4096
    ds_read_b64_tr_b16 a[156:157], v71 offset:0
    ds_read_b64_tr_b16 a[158:159], v71 offset:4096
    v_mfma_f32_16x16x32_bf16 v[40:43], v[100:103], a[36:39], v[40:43]
    ds_read_b64_tr_b16 a[160:161], v72 offset:0
    ds_read_b64_tr_b16 a[162:163], v72 offset:4096
    ds_read_b64_tr_b16 a[164:165], v73 offset:0
    v_mfma_f32_16x16x32_bf16 v[40:43], v[104:107], a[40:43], v[40:43]
    ds_read_b64_tr_b16 a[166:167], v73 offset:4096
    ds_read_b64_tr_b16 a[168:169], v74 offset:0
    v_mfma_f32_16x16x32_bf16 v[40:43], v[108:111], a[44:47], v[40:43]
    ds_read_b64_tr_b16 a[170:171], v74 offset:4096
    ds_read_b64_tr_b16 a[172:173], v75 offset:0
    ds_read_b64_tr_b16 a[174:175], v75 offset:4096
    v_mfma_f32_16x16x32_bf16 v[44:47], v[96:99], a[48:51], 0
    s_add_u32 m0, s27, 49152
    v_mfma_f32_16x16x32_bf16 v[44:47], v[100:103], a[52:55], v[44:47]
    buffer_load_dwordx4 v76, s[4:7], s28 offen offset:0 nt lds
    buffer_load_dwordx4 v77, s[4:7], s28 offen offset:1024 nt lds
    buffer_load_dwordx4 v78, s[4:7], s28 offen offset:2048 nt lds
    v_mfma_f32_16x16x32_bf16 v[44:47], v[104:107], a[56:59], v[44:47]
    buffer_load_dwordx4 v79, s[4:7], s28 offen offset:3072 nt lds
    v_exp_f32 v52, v8
    v_mfma_f32_16x16x32_bf16 v[44:47], v[108:111], a[60:63], v[44:47]
    v_exp_f32 v53, v9
    v_mfma_f32_16x16x32_bf16 v[48:51], v[96:99], a[64:67], 0
    s_mov_b32 s28, 49152
    s_add_u32 m0, s27, 114688
    s_nop 0
    buffer_load_dwordx4 v80, s[8:11], s28 offen offset:0 nt lds
    v_mfma_f32_16x16x32_bf16 v[48:51], v[100:103], a[68:71], v[48:51]
    v_exp_f32 v54, v10
    v_cvt_pk_bf16_f32 v24, v52, v53
    v_mfma_f32_16x16x32_bf16 v[48:51], v[104:107], a[72:75], v[48:51]
    buffer_load_dwordx4 v81, s[8:11], s28 offen offset:1024 nt lds
    buffer_load_dwordx4 v80, s[8:11], s28 offen offset:2048 nt lds
    v_mfma_f32_16x16x32_bf16 v[48:51], v[108:111], a[76:79], v[48:51]
    v_exp_f32 v55, v11
    v_mfma_f32_16x16x32_bf16 v[16:19], a[80:83], a[16:19], v[36:39]
    buffer_load_dwordx4 v81, s[8:11], s28 offen offset:3072 nt lds
    v_exp_f32 v52, v12
    v_mfma_f32_16x16x32_bf16 v[16:19], a[84:87], a[20:23], v[16:19]
    s_mov_b32 s28, 65536
    s_mov_b32 s29, 0
    v_cvt_pk_bf16_f32 v25, v54, v55
    v_mov_b32 v96, 0
    v_mfma_f32_16x16x32_bf16 v[16:19], a[88:91], a[24:27], v[16:19]
    v_exp_f32 v53, v13
    v_mov_b32 v97, 0
    v_mfma_f32_16x16x32_bf16 v[16:19], a[92:95], a[28:31], v[16:19]
    s_mov_b32 s16, s20
    s_mov_b32 s17, s21
    s_lshr_b32 s96, s2, 3
    v_mov_b32 v98, 0
    v_mfma_f32_16x16x32_bf16 v[20:23], a[96:99], a[16:19], v[36:39]
    v_exp_f32 v54, v14
    v_cvt_pk_bf16_f32 v26, v52, v53
    v_mov_b32 v99, 0
    v_mfma_f32_16x16x32_bf16 v[20:23], a[100:103], a[20:23], v[20:23]
    s_lshl2_add_u32 s96, s96, s26
    s_lshl_b32 s96, s96, 13
    v_mov_b32 v100, 0
    v_mov_b32 v101, 0
    v_mfma_f32_16x16x32_bf16 v[20:23], a[104:107], a[24:27], v[20:23]
    v_exp_f32 v55, v15
    s_nop 0
    v_cvt_pk_bf16_f32 v27, v54, v55
    v_mfma_f32_16x16x32_bf16 v[20:23], a[108:111], a[28:31], v[20:23]
    v_lshl_add_u32 v6, v0, 7, s96
    s_waitcnt vmcnt(16)
    s_barrier
    v_mov_b32 v102, 0
    v_mov_b32 v103, 0
    v_mov_b32 v104, 0
    v_mov_b32 v105, 0
    v_mov_b32 v106, 0
    v_mov_b32 v107, 0
    v_mov_b32 v108, 0
    v_mov_b32 v109, 0
    v_mov_b32 v110, 0
    v_mov_b32 v111, 0
    s_waitcnt lgkmcnt(0)
.p2align 6
L_loop:
    v_mfma_f32_16x16x32_bf16 v[8:11], a[80:83], a[32:35], v[40:43]
    v_exp_f32 v52, v16
    v_mfma_f32_16x16x32_bf16 v[8:11], a[84:87], a[36:39], v[8:11]
    ds_read_b128 a[112:115], v64 offset:16384
    v_mfma_f32_16x16x32_bf16 v[8:11], a[88:91], a[40:43], v[8:11]
    v_exp_f32 v53, v17
    v_mfma_f32_16x16x32_bf16 v[8:11], a[92:95], a[44:47], v[8:11]
    ds_read_b128 a[116:119], v65 offset:16384
    v_cvt_pk_bf16_f32 v28, v52, v53
    v_mfma_f32_16x16x32_bf16 v[12:15], a[96:99], a[32:35], v[40:43]
    s_add_u32 m0, s27, 0
    v_exp_f32 v54, v18
    v_mfma_f32_16x16x32_bf16 v[12:15], a[100:103], a[36:39], v[12:15]
    buffer_load_dwordx4 v76, s[4:7], s28 offen offset:0 nt lds
    v_mfma_f32_16x16x32_bf16 v[12:15], a[104:107], a[40:43], v[12:15]
    v_exp_f32 v55, v19
    v_mfma_f32_16x16x32_bf16 v[12:15], a[108:111], a[44:47], v[12:15]
    ds_read_b128 a[120:123], v66 offset:16384
    v_cvt_pk_bf16_f32 v29, v54, v55
    v_mfma_f32_16x16x32_bf16 v[96:99], a[144:147], v[24:27], v[96:99]
    v_exp_f32 v52, v20
    v_mfma_f32_16x16x32_bf16 v[116:119], a[148:151], v[24:27], v[116:119]
    ds_read_b128 a[124:127], v67 offset:16384
    v_mfma_f32_16x16x32_bf16 v[136:139], a[152:155], v[24:27], v[136:139]
    v_exp_f32 v53, v21
    v_mfma_f32_16x16x32_bf16 v[156:159], a[156:159], v[24:27], v[156:159]
    v_cvt_pk_bf16_f32 v30, v52, v53
    v_mfma_f32_16x16x32_bf16 v[176:179], a[160:163], v[24:27], v[176:179]
    v_exp_f32 v54, v22
    v_mfma_f32_16x16x32_bf16 v[196:199], a[164:167], v[24:27], v[196:199]
    buffer_load_dwordx4 v77, s[4:7], s28 offen offset:1024 nt lds
    v_mfma_f32_16x16x32_bf16 v[216:219], a[168:171], v[24:27], v[216:219]
    v_exp_f32 v55, v23
    v_mfma_f32_16x16x32_bf16 v[236:239], a[172:175], v[24:27], v[236:239]
    ds_read_b128 a[128:131], v64 offset:20480
    v_cvt_pk_bf16_f32 v31, v54, v55
    v_mfma_f32_16x16x32_bf16 v[16:19], a[80:83], a[48:51], v[44:47]
    v_exp_f32 v52, v8
    v_smfmac_f32_16x16x64_bf16 a[208:211], a[228:231], v[24:31], v60
    ds_read_b128 a[132:135], v65 offset:20480
    v_mfma_f32_16x16x32_bf16 v[16:19], a[84:87], a[52:55], v[16:19]
    ds_read_b128 a[136:139], v66 offset:20480
    v_mfma_f32_16x16x32_bf16 v[16:19], a[88:91], a[56:59], v[16:19]
    v_exp_f32 v53, v9
    v_mfma_f32_16x16x32_bf16 v[16:19], a[92:95], a[60:63], v[16:19]
    ds_read_b128 a[140:143], v67 offset:20480
    v_cvt_pk_bf16_f32 v24, v52, v53
    v_mfma_f32_16x16x32_bf16 v[20:23], a[96:99], a[48:51], v[44:47]
    v_exp_f32 v54, v10
    v_mfma_f32_16x16x32_bf16 v[20:23], a[100:103], a[52:55], v[20:23]
    buffer_load_dwordx4 v78, s[4:7], s28 offen offset:2048 nt lds
    v_mfma_f32_16x16x32_bf16 v[20:23], a[104:107], a[56:59], v[20:23]
    v_exp_f32 v55, v11
    v_mfma_f32_16x16x32_bf16 v[20:23], a[108:111], a[60:63], v[20:23]
    ds_read_b64_tr_b16 a[176:177], v68 offset:16384
    v_cvt_pk_bf16_f32 v25, v54, v55
    v_mfma_f32_16x16x32_bf16 v[100:103], a[144:147], v[28:31], v[100:103]
    v_exp_f32 v52, v12
    v_mfma_f32_16x16x32_bf16 v[120:123], a[148:151], v[28:31], v[120:123]
    ds_read_b64_tr_b16 a[178:179], v68 offset:20480
    v_mfma_f32_16x16x32_bf16 v[140:143], a[152:155], v[28:31], v[140:143]
    v_exp_f32 v53, v13
    v_mfma_f32_16x16x32_bf16 v[160:163], a[156:159], v[28:31], v[160:163]
    v_cvt_pk_bf16_f32 v26, v52, v53
    v_mfma_f32_16x16x32_bf16 v[180:183], a[160:163], v[28:31], v[180:183]
    v_exp_f32 v54, v14
    v_mfma_f32_16x16x32_bf16 v[200:203], a[164:167], v[28:31], v[200:203]
    buffer_load_dwordx4 v79, s[4:7], s28 offen offset:3072 nt lds
    v_mfma_f32_16x16x32_bf16 v[220:223], a[168:171], v[28:31], v[220:223]
    v_exp_f32 v55, v15
    v_mfma_f32_16x16x32_bf16 v[240:243], a[172:175], v[28:31], v[240:243]
    ds_read_b64_tr_b16 a[180:181], v69 offset:16384
    v_cvt_pk_bf16_f32 v27, v54, v55
    v_mfma_f32_16x16x32_bf16 v[8:11], a[80:83], a[64:67], v[48:51]
    v_exp_f32 v52, v16
    v_mfma_f32_16x16x32_bf16 v[8:11], a[84:87], a[68:71], v[8:11]
    ds_read_b64_tr_b16 a[182:183], v69 offset:20480
    v_mfma_f32_16x16x32_bf16 v[8:11], a[88:91], a[72:75], v[8:11]
    v_exp_f32 v53, v17
    v_mfma_f32_16x16x32_bf16 v[8:11], a[92:95], a[76:79], v[8:11]
    ds_read_b64_tr_b16 a[184:185], v70 offset:16384
    v_cvt_pk_bf16_f32 v28, v52, v53
    v_mfma_f32_16x16x32_bf16 v[12:15], a[96:99], a[64:67], v[48:51]
    s_lshl_b32 s18, 16384, s29
    v_exp_f32 v54, v18
    v_mfma_f32_16x16x32_bf16 v[12:15], a[100:103], a[68:71], v[12:15]
    buffer_load_dword v5, v6, s[16:19], 0 offen
    v_mfma_f32_16x16x32_bf16 v[12:15], a[104:107], a[72:75], v[12:15]
    v_exp_f32 v55, v19
    v_mfma_f32_16x16x32_bf16 v[12:15], a[108:111], a[76:79], v[12:15]
    ds_read_b64_tr_b16 a[186:187], v70 offset:20480
    v_cvt_pk_bf16_f32 v29, v54, v55
    v_mfma_f32_16x16x32_bf16 v[104:107], a[144:147], v[24:27], v[104:107]
    v_exp_f32 v52, v20
    v_mfma_f32_16x16x32_bf16 v[124:127], a[148:151], v[24:27], v[124:127]
    ds_read_b64_tr_b16 a[188:189], v71 offset:16384
    v_mfma_f32_16x16x32_bf16 v[144:147], a[152:155], v[24:27], v[144:147]
    v_exp_f32 v53, v21
    v_mfma_f32_16x16x32_bf16 v[164:167], a[156:159], v[24:27], v[164:167]
    v_cvt_pk_bf16_f32 v30, v52, v53
    v_mfma_f32_16x16x32_bf16 v[184:187], a[160:163], v[24:27], v[184:187]
    s_add_u32 m0, s27, 65536
    v_exp_f32 v54, v22
    v_mfma_f32_16x16x32_bf16 v[204:207], a[164:167], v[24:27], v[204:207]
    buffer_load_dwordx4 v80, s[8:11], s28 offen offset:0 nt lds
    v_mfma_f32_16x16x32_bf16 v[224:227], a[168:171], v[24:27], v[224:227]
    s_waitcnt lgkmcnt(7)
    v_exp_f32 v55, v23
    v_mfma_f32_16x16x32_bf16 v[244:247], a[172:175], v[24:27], v[244:247]
    ds_read_b64_tr_b16 a[190:191], v71 offset:20480
    v_cvt_pk_bf16_f32 v31, v54, v55
    v_mfma_f32_16x16x32_bf16 v[16:19], a[112:115], a[0:3], v[32:35]
    v_exp_f32 v52, v8
    v_smfmac_f32_16x16x64_bf16 a[216:219], a[228:231], v[24:31], v60
    ds_read_b64_tr_b16 a[192:193], v72 offset:16384
    v_mfma_f32_16x16x32_bf16 v[16:19], a[116:119], a[4:7], v[16:19]
    ds_read_b64_tr_b16 a[194:195], v72 offset:20480
    v_mfma_f32_16x16x32_bf16 v[16:19], a[120:123], a[8:11], v[16:19]
    v_exp_f32 v53, v9
    v_mfma_f32_16x16x32_bf16 v[16:19], a[124:127], a[12:15], v[16:19]
    ds_read_b64_tr_b16 a[196:197], v73 offset:16384
    v_cvt_pk_bf16_f32 v24, v52, v53
    v_mfma_f32_16x16x32_bf16 v[20:23], a[128:131], a[0:3], v[32:35]
    v_exp_f32 v54, v10
    v_mfma_f32_16x16x32_bf16 v[20:23], a[132:135], a[4:7], v[20:23]
    buffer_load_dwordx4 v81, s[8:11], s28 offen offset:1024 nt lds
    v_mfma_f32_16x16x32_bf16 v[20:23], a[136:139], a[8:11], v[20:23]
    v_exp_f32 v55, v11
    v_mfma_f32_16x16x32_bf16 v[20:23], a[140:143], a[12:15], v[20:23]
    ds_read_b64_tr_b16 a[198:199], v73 offset:20480
    v_cvt_pk_bf16_f32 v25, v54, v55
    v_mfma_f32_16x16x32_bf16 v[108:111], a[144:147], v[28:31], v[108:111]
    v_exp_f32 v52, v12
    v_mfma_f32_16x16x32_bf16 v[128:131], a[148:151], v[28:31], v[128:131]
    ds_read_b64_tr_b16 a[200:201], v74 offset:16384
    v_mfma_f32_16x16x32_bf16 v[148:151], a[152:155], v[28:31], v[148:151]
    v_exp_f32 v53, v13
    v_mfma_f32_16x16x32_bf16 v[168:171], a[156:159], v[28:31], v[168:171]
    v_cvt_pk_bf16_f32 v26, v52, v53
    v_mfma_f32_16x16x32_bf16 v[188:191], a[160:163], v[28:31], v[188:191]
    v_exp_f32 v54, v14
    v_mfma_f32_16x16x32_bf16 v[208:211], a[164:167], v[28:31], v[208:211]
    buffer_load_dwordx4 v80, s[8:11], s28 offen offset:2048 nt lds
    v_mfma_f32_16x16x32_bf16 v[228:231], a[168:171], v[28:31], v[228:231]
    v_exp_f32 v55, v15
    v_mfma_f32_16x16x32_bf16 v[248:251], a[172:175], v[28:31], v[248:251]
    ds_read_b64_tr_b16 a[202:203], v74 offset:20480
    v_cvt_pk_bf16_f32 v27, v54, v55
    v_mfma_f32_16x16x32_bf16 v[8:11], a[112:115], a[16:19], v[36:39]
    v_exp_f32 v52, v16
    v_mfma_f32_16x16x32_bf16 v[8:11], a[116:119], a[20:23], v[8:11]
    ds_read_b64_tr_b16 a[204:205], v75 offset:16384
    v_mfma_f32_16x16x32_bf16 v[8:11], a[120:123], a[24:27], v[8:11]
    v_exp_f32 v53, v17
    v_mfma_f32_16x16x32_bf16 v[8:11], a[124:127], a[28:31], v[8:11]
    ds_read_b64_tr_b16 a[206:207], v75 offset:20480
    v_cvt_pk_bf16_f32 v28, v52, v53
    v_mfma_f32_16x16x32_bf16 v[12:15], a[128:131], a[16:19], v[36:39]
    v_exp_f32 v54, v18
    v_mfma_f32_16x16x32_bf16 v[12:15], a[132:135], a[20:23], v[12:15]
    buffer_load_dwordx4 v81, s[8:11], s28 offen offset:3072 nt lds
    v_mfma_f32_16x16x32_bf16 v[12:15], a[136:139], a[24:27], v[12:15]
    s_add_u32 s28, s28, 16384
    v_exp_f32 v55, v19
    v_mfma_f32_16x16x32_bf16 v[12:15], a[140:143], a[28:31], v[12:15]
    v_cvt_pk_bf16_f32 v29, v54, v55
    v_mfma_f32_16x16x32_bf16 v[112:115], a[144:147], v[24:27], v[112:115]
    v_exp_f32 v52, v20
    v_mfma_f32_16x16x32_bf16 v[132:135], a[148:151], v[24:27], v[132:135]
    v_mfma_f32_16x16x32_bf16 v[152:155], a[152:155], v[24:27], v[152:155]
    v_exp_f32 v53, v21
    v_mfma_f32_16x16x32_bf16 v[172:175], a[156:159], v[24:27], v[172:175]
    v_cvt_pk_bf16_f32 v30, v52, v53
    v_mfma_f32_16x16x32_bf16 v[192:195], a[160:163], v[24:27], v[192:195]
    s_waitcnt vmcnt(17) lgkmcnt(0)
    v_exp_f32 v54, v22
    v_mfma_f32_16x16x32_bf16 v[212:215], a[164:167], v[24:27], v[212:215]
    s_barrier
    v_mfma_f32_16x16x32_bf16 v[232:235], a[168:171], v[24:27], v[232:235]
    v_exp_f32 v55, v23
    v_mfma_f32_16x16x32_bf16 v[252:255], a[172:175], v[24:27], v[252:255]
    v_cvt_pk_bf16_f32 v31, v54, v55
    v_mfma_f32_16x16x32_bf16 v[16:19], a[112:115], a[32:35], v[40:43]
    v_exp_f32 v52, v8
    v_smfmac_f32_16x16x64_bf16 a[212:215], a[228:231], v[24:31], v60
    ds_read_b128 a[80:83], v64 offset:32768
    v_mfma_f32_16x16x32_bf16 v[16:19], a[116:119], a[36:39], v[16:19]
    ds_read_b128 a[84:87], v65 offset:32768
    v_mfma_f32_16x16x32_bf16 v[16:19], a[120:123], a[40:43], v[16:19]
    v_exp_f32 v53, v9
    v_mfma_f32_16x16x32_bf16 v[16:19], a[124:127], a[44:47], v[16:19]
    ds_read_b128 a[88:91], v66 offset:32768
    v_cvt_pk_bf16_f32 v24, v52, v53
    v_mfma_f32_16x16x32_bf16 v[20:23], a[128:131], a[32:35], v[40:43]
    s_add_u32 m0, s27, 16384
    v_exp_f32 v54, v10
    v_mfma_f32_16x16x32_bf16 v[20:23], a[132:135], a[36:39], v[20:23]
    buffer_load_dwordx4 v76, s[4:7], s28 offen offset:0 nt lds
    v_mfma_f32_16x16x32_bf16 v[20:23], a[136:139], a[40:43], v[20:23]
    v_exp_f32 v55, v11
    v_mfma_f32_16x16x32_bf16 v[20:23], a[140:143], a[44:47], v[20:23]
    v_cvt_pk_bf16_f32 v25, v54, v55
    v_mfma_f32_16x16x32_bf16 v[96:99], a[176:179], v[28:31], v[96:99]
    v_exp_f32 v52, v12
    v_mfma_f32_16x16x32_bf16 v[116:119], a[180:183], v[28:31], v[116:119]
    ds_read_b128 a[92:95], v67 offset:32768
    v_mfma_f32_16x16x32_bf16 v[136:139], a[184:187], v[28:31], v[136:139]
    v_exp_f32 v53, v13
    v_mfma_f32_16x16x32_bf16 v[156:159], a[188:191], v[28:31], v[156:159]
    ds_read_b128 a[96:99], v64 offset:36864
    v_cvt_pk_bf16_f32 v26, v52, v53
    v_mfma_f32_16x16x32_bf16 v[176:179], a[192:195], v[28:31], v[176:179]
    v_exp_f32 v54, v14
    v_mfma_f32_16x16x32_bf16 v[196:199], a[196:199], v[28:31], v[196:199]
    buffer_load_dwordx4 v77, s[4:7], s28 offen offset:1024 nt lds
    v_mfma_f32_16x16x32_bf16 v[216:219], a[200:203], v[28:31], v[216:219]
    v_exp_f32 v55, v15
    v_mfma_f32_16x16x32_bf16 v[236:239], a[204:207], v[28:31], v[236:239]
    ds_read_b128 a[100:103], v65 offset:36864
    v_cvt_pk_bf16_f32 v27, v54, v55
    v_mfma_f32_16x16x32_bf16 v[8:11], a[112:115], a[48:51], v[44:47]
    v_exp_f32 v52, v16
    v_mfma_f32_16x16x32_bf16 v[8:11], a[116:119], a[52:55], v[8:11]
    ds_read_b128 a[104:107], v66 offset:36864
    v_mfma_f32_16x16x32_bf16 v[8:11], a[120:123], a[56:59], v[8:11]
    v_exp_f32 v53, v17
    v_mfma_f32_16x16x32_bf16 v[8:11], a[124:127], a[60:63], v[8:11]
    v_cvt_pk_bf16_f32 v28, v52, v53
    v_mfma_f32_16x16x32_bf16 v[12:15], a[128:131], a[48:51], v[44:47]
    v_exp_f32 v54, v18
    v_mfma_f32_16x16x32_bf16 v[12:15], a[132:135], a[52:55], v[12:15]
    buffer_load_dwordx4 v78, s[4:7], s28 offen offset:2048 nt lds
    v_mfma_f32_16x16x32_bf16 v[12:15], a[136:139], a[56:59], v[12:15]
    v_exp_f32 v55, v19
    v_mfma_f32_16x16x32_bf16 v[12:15], a[140:143], a[60:63], v[12:15]
    ds_read_b128 a[108:111], v67 offset:36864
    v_cvt_pk_bf16_f32 v29, v54, v55
    v_mfma_f32_16x16x32_bf16 v[100:103], a[176:179], v[24:27], v[100:103]
    v_exp_f32 v52, v20
    v_mfma_f32_16x16x32_bf16 v[120:123], a[180:183], v[24:27], v[120:123]
    ds_read_b64_tr_b16 a[144:145], v68 offset:32768
    v_mfma_f32_16x16x32_bf16 v[140:143], a[184:187], v[24:27], v[140:143]
    v_exp_f32 v53, v21
    v_mfma_f32_16x16x32_bf16 v[160:163], a[188:191], v[24:27], v[160:163]
    ds_read_b64_tr_b16 a[146:147], v68 offset:36864
    v_cvt_pk_bf16_f32 v30, v52, v53
    v_mfma_f32_16x16x32_bf16 v[180:183], a[192:195], v[24:27], v[180:183]
    v_exp_f32 v54, v22
    v_mfma_f32_16x16x32_bf16 v[200:203], a[196:199], v[24:27], v[200:203]
    ds_read_b64_tr_b16 a[148:149], v69 offset:32768
    v_mfma_f32_16x16x32_bf16 v[220:223], a[200:203], v[24:27], v[220:223]
    v_exp_f32 v55, v23
    v_mfma_f32_16x16x32_bf16 v[240:243], a[204:207], v[24:27], v[240:243]
    v_cvt_pk_bf16_f32 v31, v54, v55
    v_mfma_f32_16x16x32_bf16 v[16:19], a[112:115], a[64:67], v[48:51]
    v_exp_f32 v52, v8
    v_smfmac_f32_16x16x64_bf16 a[220:223], a[228:231], v[24:31], v60
    ds_read_b64_tr_b16 a[150:151], v69 offset:36864
    v_mfma_f32_16x16x32_bf16 v[16:19], a[116:119], a[68:71], v[16:19]
    buffer_load_dwordx4 v79, s[4:7], s28 offen offset:3072 nt lds
    v_mfma_f32_16x16x32_bf16 v[16:19], a[120:123], a[72:75], v[16:19]
    v_exp_f32 v53, v9
    v_mfma_f32_16x16x32_bf16 v[16:19], a[124:127], a[76:79], v[16:19]
    ds_read_b64_tr_b16 a[152:153], v70 offset:32768
    v_cvt_pk_bf16_f32 v24, v52, v53
    v_mfma_f32_16x16x32_bf16 v[20:23], a[128:131], a[64:67], v[48:51]
    v_exp_f32 v54, v10
    v_mfma_f32_16x16x32_bf16 v[20:23], a[132:135], a[68:71], v[20:23]
    ds_read_b64_tr_b16 a[154:155], v70 offset:36864
    v_mfma_f32_16x16x32_bf16 v[20:23], a[136:139], a[72:75], v[20:23]
    v_exp_f32 v55, v11
    v_mfma_f32_16x16x32_bf16 v[20:23], a[140:143], a[76:79], v[20:23]
    v_cvt_pk_bf16_f32 v25, v54, v55
    v_mfma_f32_16x16x32_bf16 v[104:107], a[176:179], v[28:31], v[104:107]
    s_add_u32 m0, s27, 81920
    v_exp_f32 v52, v12
    v_mfma_f32_16x16x32_bf16 v[124:127], a[180:183], v[28:31], v[124:127]
    buffer_load_dwordx4 v80, s[8:11], s28 offen offset:0 nt lds
    v_mfma_f32_16x16x32_bf16 v[144:147], a[184:187], v[28:31], v[144:147]
    v_exp_f32 v53, v13
    v_mfma_f32_16x16x32_bf16 v[164:167], a[188:191], v[28:31], v[164:167]
    ds_read_b64_tr_b16 a[156:157], v71 offset:32768
    v_cvt_pk_bf16_f32 v26, v52, v53
    v_mfma_f32_16x16x32_bf16 v[184:187], a[192:195], v[28:31], v[184:187]
    v_exp_f32 v54, v14
    v_mfma_f32_16x16x32_bf16 v[204:207], a[196:199], v[28:31], v[204:207]
    ds_read_b64_tr_b16 a[158:159], v71 offset:36864
    v_mfma_f32_16x16x32_bf16 v[224:227], a[200:203], v[28:31], v[224:227]
    s_waitcnt lgkmcnt(8)
    v_exp_f32 v55, v15
    v_mfma_f32_16x16x32_bf16 v[244:247], a[204:207], v[28:31], v[244:247]
    ds_read_b64_tr_b16 a[160:161], v72 offset:32768
    v_cvt_pk_bf16_f32 v27, v54, v55
    v_mfma_f32_16x16x32_bf16 v[8:11], a[80:83], a[0:3], v[32:35]
    v_exp_f32 v52, v16
    v_mfma_f32_16x16x32_bf16 v[8:11], a[84:87], a[4:7], v[8:11]
    ds_read_b64_tr_b16 a[162:163], v72 offset:36864
    v_mfma_f32_16x16x32_bf16 v[8:11], a[88:91], a[8:11], v[8:11]
    v_exp_f32 v53, v17
    v_mfma_f32_16x16x32_bf16 v[8:11], a[92:95], a[12:15], v[8:11]
    v_cvt_pk_bf16_f32 v28, v52, v53
    v_mfma_f32_16x16x32_bf16 v[12:15], a[96:99], a[0:3], v[32:35]
    v_exp_f32 v54, v18
    v_mfma_f32_16x16x32_bf16 v[12:15], a[100:103], a[4:7], v[12:15]
    buffer_load_dwordx4 v81, s[8:11], s28 offen offset:1024 nt lds
    v_mfma_f32_16x16x32_bf16 v[12:15], a[104:107], a[8:11], v[12:15]
    v_exp_f32 v55, v19
    v_mfma_f32_16x16x32_bf16 v[12:15], a[108:111], a[12:15], v[12:15]
    ds_read_b64_tr_b16 a[164:165], v73 offset:32768
    v_cvt_pk_bf16_f32 v29, v54, v55
    v_mfma_f32_16x16x32_bf16 v[108:111], a[176:179], v[24:27], v[108:111]
    v_exp_f32 v52, v20
    v_mfma_f32_16x16x32_bf16 v[128:131], a[180:183], v[24:27], v[128:131]
    ds_read_b64_tr_b16 a[166:167], v73 offset:36864
    v_mfma_f32_16x16x32_bf16 v[148:151], a[184:187], v[24:27], v[148:151]
    v_exp_f32 v53, v21
    v_mfma_f32_16x16x32_bf16 v[168:171], a[188:191], v[24:27], v[168:171]
    ds_read_b64_tr_b16 a[168:169], v74 offset:32768
    v_cvt_pk_bf16_f32 v30, v52, v53
    v_mfma_f32_16x16x32_bf16 v[188:191], a[192:195], v[24:27], v[188:191]
    v_exp_f32 v54, v22
    v_mfma_f32_16x16x32_bf16 v[208:211], a[196:199], v[24:27], v[208:211]
    buffer_load_dwordx4 v80, s[8:11], s28 offen offset:2048 nt lds
    v_mfma_f32_16x16x32_bf16 v[228:231], a[200:203], v[24:27], v[228:231]
    v_exp_f32 v55, v23
    v_mfma_f32_16x16x32_bf16 v[248:251], a[204:207], v[24:27], v[248:251]
    v_cvt_pk_bf16_f32 v31, v54, v55
    v_mfma_f32_16x16x32_bf16 v[16:19], a[80:83], a[16:19], v[36:39]
    v_exp_f32 v52, v8
    v_smfmac_f32_16x16x64_bf16 a[224:227], a[228:231], v[24:31], v60
    ds_read_b64_tr_b16 a[170:171], v74 offset:36864
    v_mfma_f32_16x16x32_bf16 v[16:19], a[84:87], a[20:23], v[16:19]
    ds_read_b64_tr_b16 a[172:173], v75 offset:32768
    v_mfma_f32_16x16x32_bf16 v[16:19], a[88:91], a[24:27], v[16:19]
    v_exp_f32 v53, v9
    v_mfma_f32_16x16x32_bf16 v[16:19], a[92:95], a[28:31], v[16:19]
    ds_read_b64_tr_b16 a[174:175], v75 offset:36864
    v_cvt_pk_bf16_f32 v24, v52, v53
    v_mfma_f32_16x16x32_bf16 v[20:23], a[96:99], a[16:19], v[36:39]
    v_exp_f32 v54, v10
    v_mfma_f32_16x16x32_bf16 v[20:23], a[100:103], a[20:23], v[20:23]
    buffer_load_dwordx4 v81, s[8:11], s28 offen offset:3072 nt lds
    v_mfma_f32_16x16x32_bf16 v[20:23], a[104:107], a[24:27], v[20:23]
    s_add_u32 s28, s28, 16384
    v_exp_f32 v55, v11
    v_mfma_f32_16x16x32_bf16 v[20:23], a[108:111], a[28:31], v[20:23]
    v_cvt_pk_bf16_f32 v25, v54, v55
    v_mfma_f32_16x16x32_bf16 v[112:115], a[176:179], v[28:31], v[112:115]
    v_exp_f32 v52, v12
    v_mfma_f32_16x16x32_bf16 v[132:135], a[180:183], v[28:31], v[132:135]
    v_mfma_f32_16x16x32_bf16 v[152:155], a[184:187], v[28:31], v[152:155]
    v_exp_f32 v53, v13
    v_mfma_f32_16x16x32_bf16 v[172:175], a[188:191], v[28:31], v[172:175]
    v_cvt_pk_bf16_f32 v26, v52, v53
    v_mfma_f32_16x16x32_bf16 v[192:195], a[192:195], v[28:31], v[192:195]
    s_waitcnt vmcnt(17) lgkmcnt(0)
    v_exp_f32 v54, v14
    v_mfma_f32_16x16x32_bf16 v[212:215], a[196:199], v[28:31], v[212:215]
    s_barrier
    v_mfma_f32_16x16x32_bf16 v[232:235], a[200:203], v[28:31], v[232:235]
    v_exp_f32 v55, v15
    v_mfma_f32_16x16x32_bf16 v[252:255], a[204:207], v[28:31], v[252:255]
    v_cvt_pk_bf16_f32 v27, v54, v55
    v_mfma_f32_16x16x32_bf16 v[8:11], a[80:83], a[32:35], v[40:43]
    v_exp_f32 v52, v16
    v_mfma_f32_16x16x32_bf16 v[8:11], a[84:87], a[36:39], v[8:11]
    ds_read_b128 a[112:115], v64 offset:49152
    v_mfma_f32_16x16x32_bf16 v[8:11], a[88:91], a[40:43], v[8:11]
    v_exp_f32 v53, v17
    v_mfma_f32_16x16x32_bf16 v[8:11], a[92:95], a[44:47], v[8:11]
    ds_read_b128 a[116:119], v65 offset:49152
    v_cvt_pk_bf16_f32 v28, v52, v53
    v_mfma_f32_16x16x32_bf16 v[12:15], a[96:99], a[32:35], v[40:43]
    s_add_u32 m0, s27, 32768
    v_exp_f32 v54, v18
    v_mfma_f32_16x16x32_bf16 v[12:15], a[100:103], a[36:39], v[12:15]
    buffer_load_dwordx4 v76, s[4:7], s28 offen offset:0 nt lds
    v_mfma_f32_16x16x32_bf16 v[12:15], a[104:107], a[40:43], v[12:15]
    v_exp_f32 v55, v19
    v_mfma_f32_16x16x32_bf16 v[12:15], a[108:111], a[44:47], v[12:15]
    v_cvt_pk_bf16_f32 v29, v54, v55
    v_mfma_f32_16x16x32_bf16 v[96:99], a[144:147], v[24:27], v[96:99]
    v_exp_f32 v52, v20
    v_mfma_f32_16x16x32_bf16 v[116:119], a[148:151], v[24:27], v[116:119]
    ds_read_b128 a[120:123], v66 offset:49152
    v_mfma_f32_16x16x32_bf16 v[136:139], a[152:155], v[24:27], v[136:139]
    v_exp_f32 v53, v21
    v_mfma_f32_16x16x32_bf16 v[156:159], a[156:159], v[24:27], v[156:159]
    ds_read_b128 a[124:127], v67 offset:49152
    v_cvt_pk_bf16_f32 v30, v52, v53
    v_mfma_f32_16x16x32_bf16 v[176:179], a[160:163], v[24:27], v[176:179]
    v_exp_f32 v54, v22
    v_mfma_f32_16x16x32_bf16 v[196:199], a[164:167], v[24:27], v[196:199]
    buffer_load_dwordx4 v77, s[4:7], s28 offen offset:1024 nt lds
    v_mfma_f32_16x16x32_bf16 v[216:219], a[168:171], v[24:27], v[216:219]
    v_exp_f32 v55, v23
    v_mfma_f32_16x16x32_bf16 v[236:239], a[172:175], v[24:27], v[236:239]
    ds_read_b128 a[128:131], v64 offset:53248
    v_cvt_pk_bf16_f32 v31, v54, v55
    v_mfma_f32_16x16x32_bf16 v[16:19], a[80:83], a[48:51], v[44:47]
    v_exp_f32 v52, v8
    v_smfmac_f32_16x16x64_bf16 a[208:211], a[228:231], v[24:31], v60
    ds_read_b128 a[132:135], v65 offset:53248
    v_mfma_f32_16x16x32_bf16 v[16:19], a[84:87], a[52:55], v[16:19]
    ds_read_b128 a[136:139], v66 offset:53248
    v_mfma_f32_16x16x32_bf16 v[16:19], a[88:91], a[56:59], v[16:19]
    v_exp_f32 v53, v9
    v_mfma_f32_16x16x32_bf16 v[16:19], a[92:95], a[60:63], v[16:19]
    ds_read_b128 a[140:143], v67 offset:53248
    v_cvt_pk_bf16_f32 v24, v52, v53
    v_mfma_f32_16x16x32_bf16 v[20:23], a[96:99], a[48:51], v[44:47]
    v_exp_f32 v54, v10
    v_mfma_f32_16x16x32_bf16 v[20:23], a[100:103], a[52:55], v[20:23]
    buffer_load_dwordx4 v78, s[4:7], s28 offen offset:2048 nt lds
    v_mfma_f32_16x16x32_bf16 v[20:23], a[104:107], a[56:59], v[20:23]
    v_exp_f32 v55, v11
    v_mfma_f32_16x16x32_bf16 v[20:23], a[108:111], a[60:63], v[20:23]
    v_cvt_pk_bf16_f32 v25, v54, v55
    v_mfma_f32_16x16x32_bf16 v[100:103], a[144:147], v[28:31], v[100:103]
    v_exp_f32 v52, v12
    v_mfma_f32_16x16x32_bf16 v[120:123], a[148:151], v[28:31], v[120:123]
    ds_read_b64_tr_b16 a[176:177], v68 offset:49152
    v_mfma_f32_16x16x32_bf16 v[140:143], a[152:155], v[28:31], v[140:143]
    v_exp_f32 v53, v13
    v_mfma_f32_16x16x32_bf16 v[160:163], a[156:159], v[28:31], v[160:163]
    ds_read_b64_tr_b16 a[178:179], v68 offset:53248
    v_cvt_pk_bf16_f32 v26, v52, v53
    v_mfma_f32_16x16x32_bf16 v[180:183], a[160:163], v[28:31], v[180:183]
    v_exp_f32 v54, v14
    v_mfma_f32_16x16x32_bf16 v[200:203], a[164:167], v[28:31], v[200:203]
    ds_read_b64_tr_b16 a[180:181], v69 offset:49152
    v_mfma_f32_16x16x32_bf16 v[220:223], a[168:171], v[28:31], v[220:223]
    v_exp_f32 v55, v15
    v_mfma_f32_16x16x32_bf16 v[240:243], a[172:175], v[28:31], v[240:243]
    ds_read_b64_tr_b16 a[182:183], v69 offset:53248
    v_cvt_pk_bf16_f32 v27, v54, v55
    v_mfma_f32_16x16x32_bf16 v[8:11], a[80:83], a[64:67], v[48:51]
    v_exp_f32 v52, v16
    v_mfma_f32_16x16x32_bf16 v[8:11], a[84:87], a[68:71], v[8:11]
    buffer_load_dwordx4 v79, s[4:7], s28 offen offset:3072 nt lds
    v_mfma_f32_16x16x32_bf16 v[8:11], a[88:91], a[72:75], v[8:11]
    v_exp_f32 v53, v17
    v_mfma_f32_16x16x32_bf16 v[8:11], a[92:95], a[76:79], v[8:11]
    v_cvt_pk_bf16_f32 v28, v52, v53
    v_mfma_f32_16x16x32_bf16 v[12:15], a[96:99], a[64:67], v[48:51]
    v_exp_f32 v54, v18
    v_mfma_f32_16x16x32_bf16 v[12:15], a[100:103], a[68:71], v[12:15]
    ds_read_b64_tr_b16 a[184:185], v70 offset:49152
    v_mfma_f32_16x16x32_bf16 v[12:15], a[104:107], a[72:75], v[12:15]
    v_exp_f32 v55, v19
    v_mfma_f32_16x16x32_bf16 v[12:15], a[108:111], a[76:79], v[12:15]
    ds_read_b64_tr_b16 a[186:187], v70 offset:53248
    v_cvt_pk_bf16_f32 v29, v54, v55
    v_mfma_f32_16x16x32_bf16 v[104:107], a[144:147], v[24:27], v[104:107]
    s_add_u32 m0, s27, 98304
    v_exp_f32 v52, v20
    v_mfma_f32_16x16x32_bf16 v[124:127], a[148:151], v[24:27], v[124:127]
    buffer_load_dwordx4 v80, s[8:11], s28 offen offset:0 nt lds
    v_mfma_f32_16x16x32_bf16 v[144:147], a[152:155], v[24:27], v[144:147]
    v_exp_f32 v53, v21
    v_mfma_f32_16x16x32_bf16 v[164:167], a[156:159], v[24:27], v[164:167]
    ds_read_b64_tr_b16 a[188:189], v71 offset:49152
    v_cvt_pk_bf16_f32 v30, v52, v53
    v_mfma_f32_16x16x32_bf16 v[184:187], a[160:163], v[24:27], v[184:187]
    v_exp_f32 v54, v22
    v_mfma_f32_16x16x32_bf16 v[204:207], a[164:167], v[24:27], v[204:207]
    ds_read_b64_tr_b16 a[190:191], v71 offset:53248
    v_mfma_f32_16x16x32_bf16 v[224:227], a[168:171], v[24:27], v[224:227]
    s_waitcnt lgkmcnt(8)
    v_exp_f32 v55, v23
    v_mfma_f32_16x16x32_bf16 v[244:247], a[172:175], v[24:27], v[244:247]
    v_cvt_pk_bf16_f32 v31, v54, v55
    v_mfma_f32_16x16x32_bf16 v[16:19], a[112:115], a[0:3], v[32:35]
    v_exp_f32 v52, v8
    v_smfmac_f32_16x16x64_bf16 a[216:219], a[228:231], v[24:31], v60
    ds_read_b64_tr_b16 a[192:193], v72 offset:49152
    v_mfma_f32_16x16x32_bf16 v[16:19], a[116:119], a[4:7], v[16:19]
    ds_read_b64_tr_b16 a[194:195], v72 offset:53248
    v_mfma_f32_16x16x32_bf16 v[16:19], a[120:123], a[8:11], v[16:19]
    v_exp_f32 v53, v9
    v_mfma_f32_16x16x32_bf16 v[16:19], a[124:127], a[12:15], v[16:19]
    ds_read_b64_tr_b16 a[196:197], v73 offset:49152
    v_cvt_pk_bf16_f32 v24, v52, v53
    v_mfma_f32_16x16x32_bf16 v[20:23], a[128:131], a[0:3], v[32:35]
    v_exp_f32 v54, v10
    v_mfma_f32_16x16x32_bf16 v[20:23], a[132:135], a[4:7], v[20:23]
    buffer_load_dwordx4 v81, s[8:11], s28 offen offset:1024 nt lds
    v_mfma_f32_16x16x32_bf16 v[20:23], a[136:139], a[8:11], v[20:23]
    v_exp_f32 v55, v11
    v_mfma_f32_16x16x32_bf16 v[20:23], a[140:143], a[12:15], v[20:23]
    ds_read_b64_tr_b16 a[198:199], v73 offset:53248
    v_cvt_pk_bf16_f32 v25, v54, v55
    v_mfma_f32_16x16x32_bf16 v[108:111], a[144:147], v[28:31], v[108:111]
    v_exp_f32 v52, v12
    v_mfma_f32_16x16x32_bf16 v[128:131], a[148:151], v[28:31], v[128:131]
    ds_read_b64_tr_b16 a[200:201], v74 offset:49152
    v_mfma_f32_16x16x32_bf16 v[148:151], a[152:155], v[28:31], v[148:151]
    v_exp_f32 v53, v13
    v_mfma_f32_16x16x32_bf16 v[168:171], a[156:159], v[28:31], v[168:171]
    ds_read_b64_tr_b16 a[202:203], v74 offset:53248
    v_cvt_pk_bf16_f32 v26, v52, v53
    v_mfma_f32_16x16x32_bf16 v[188:191], a[160:163], v[28:31], v[188:191]
    v_exp_f32 v54, v14
    v_mfma_f32_16x16x32_bf16 v[208:211], a[164:167], v[28:31], v[208:211]
    buffer_load_dwordx4 v80, s[8:11], s28 offen offset:2048 nt lds
    v_mfma_f32_16x16x32_bf16 v[228:231], a[168:171], v[28:31], v[228:231]
    v_exp_f32 v55, v15
    v_mfma_f32_16x16x32_bf16 v[248:251], a[172:175], v[28:31], v[248:251]
    v_cvt_pk_bf16_f32 v27, v54, v55
    v_mfma_f32_16x16x32_bf16 v[8:11], a[112:115], a[16:19], v[36:39]
    v_exp_f32 v52, v16
    v_mfma_f32_16x16x32_bf16 v[8:11], a[116:119], a[20:23], v[8:11]
    ds_read_b64_tr_b16 a[204:205], v75 offset:49152
    v_mfma_f32_16x16x32_bf16 v[8:11], a[120:123], a[24:27], v[8:11]
    v_exp_f32 v53, v17
    v_mfma_f32_16x16x32_bf16 v[8:11], a[124:127], a[28:31], v[8:11]
    ds_read_b64_tr_b16 a[206:207], v75 offset:53248
    v_cvt_pk_bf16_f32 v28, v52, v53
    v_mfma_f32_16x16x32_bf16 v[12:15], a[128:131], a[16:19], v[36:39]
    v_exp_f32 v54, v18
    v_mfma_f32_16x16x32_bf16 v[12:15], a[132:135], a[20:23], v[12:15]
    buffer_load_dwordx4 v81, s[8:11], s28 offen offset:3072 nt lds
    v_mfma_f32_16x16x32_bf16 v[12:15], a[136:139], a[24:27], v[12:15]
    s_add_u32 s28, s28, 16384
    v_exp_f32 v55, v19
    v_mfma_f32_16x16x32_bf16 v[12:15], a[140:143], a[28:31], v[12:15]
    v_cvt_pk_bf16_f32 v29, v54, v55
    v_mfma_f32_16x16x32_bf16 v[112:115], a[144:147], v[24:27], v[112:115]
    v_exp_f32 v52, v20
    v_mfma_f32_16x16x32_bf16 v[132:135], a[148:151], v[24:27], v[132:135]
    v_mfma_f32_16x16x32_bf16 v[152:155], a[152:155], v[24:27], v[152:155]
    v_exp_f32 v53, v21
    v_mfma_f32_16x16x32_bf16 v[172:175], a[156:159], v[24:27], v[172:175]
    v_cvt_pk_bf16_f32 v30, v52, v53
    v_mfma_f32_16x16x32_bf16 v[192:195], a[160:163], v[24:27], v[192:195]
    s_waitcnt vmcnt(16) lgkmcnt(0)
    v_exp_f32 v54, v22
    v_mfma_f32_16x16x32_bf16 v[212:215], a[164:167], v[24:27], v[212:215]
    s_barrier
    v_mfma_f32_16x16x32_bf16 v[232:235], a[168:171], v[24:27], v[232:235]
    v_exp_f32 v55, v23
    v_mfma_f32_16x16x32_bf16 v[252:255], a[172:175], v[24:27], v[252:255]
    v_cvt_pk_bf16_f32 v31, v54, v55
    v_mfma_f32_16x16x32_bf16 v[16:19], a[112:115], a[32:35], v[40:43]
    v_exp_f32 v52, v8
    v_smfmac_f32_16x16x64_bf16 a[212:215], a[228:231], v[24:31], v60
    ds_read_b128 a[80:83], v64 offset:0
    v_mfma_f32_16x16x32_bf16 v[16:19], a[116:119], a[36:39], v[16:19]
    ds_read_b128 a[84:87], v65 offset:0
    v_mfma_f32_16x16x32_bf16 v[16:19], a[120:123], a[40:43], v[16:19]
    v_exp_f32 v53, v9
    v_mfma_f32_16x16x32_bf16 v[16:19], a[124:127], a[44:47], v[16:19]
    ds_read_b128 a[88:91], v66 offset:0
    v_cvt_pk_bf16_f32 v24, v52, v53
    v_mfma_f32_16x16x32_bf16 v[20:23], a[128:131], a[32:35], v[40:43]
    s_add_u32 m0, s27, 49152
    v_exp_f32 v54, v10
    v_mfma_f32_16x16x32_bf16 v[20:23], a[132:135], a[36:39], v[20:23]
    buffer_load_dwordx4 v76, s[4:7], s28 offen offset:0 nt lds
    v_mfma_f32_16x16x32_bf16 v[20:23], a[136:139], a[40:43], v[20:23]
    v_exp_f32 v55, v11
    v_mfma_f32_16x16x32_bf16 v[20:23], a[140:143], a[44:47], v[20:23]
    v_cvt_pk_bf16_f32 v25, v54, v55
    v_mfma_f32_16x16x32_bf16 v[96:99], a[176:179], v[28:31], v[96:99]
    v_exp_f32 v52, v12
    v_mfma_f32_16x16x32_bf16 v[116:119], a[180:183], v[28:31], v[116:119]
    ds_read_b128 a[92:95], v67 offset:0
    v_mfma_f32_16x16x32_bf16 v[136:139], a[184:187], v[28:31], v[136:139]
    v_exp_f32 v53, v13
    v_mfma_f32_16x16x32_bf16 v[156:159], a[188:191], v[28:31], v[156:159]
    ds_read_b128 a[96:99], v64 offset:4096
    v_cvt_pk_bf16_f32 v26, v52, v53
    v_mfma_f32_16x16x32_bf16 v[176:179], a[192:195], v[28:31], v[176:179]
    v_exp_f32 v54, v14
    v_mfma_f32_16x16x32_bf16 v[196:199], a[196:199], v[28:31], v[196:199]
    buffer_load_dwordx4 v77, s[4:7], s28 offen offset:1024 nt lds
    v_mfma_f32_16x16x32_bf16 v[216:219], a[200:203], v[28:31], v[216:219]
    v_exp_f32 v55, v15
    v_mfma_f32_16x16x32_bf16 v[236:239], a[204:207], v[28:31], v[236:239]
    ds_read_b128 a[100:103], v65 offset:4096
    v_cvt_pk_bf16_f32 v27, v54, v55
    v_mfma_f32_16x16x32_bf16 v[8:11], a[112:115], a[48:51], v[44:47]
    v_exp_f32 v52, v16
    v_mfma_f32_16x16x32_bf16 v[8:11], a[116:119], a[52:55], v[8:11]
    ds_read_b128 a[104:107], v66 offset:4096
    v_mfma_f32_16x16x32_bf16 v[8:11], a[120:123], a[56:59], v[8:11]
    v_exp_f32 v53, v17
    v_mfma_f32_16x16x32_bf16 v[8:11], a[124:127], a[60:63], v[8:11]
    v_cvt_pk_bf16_f32 v28, v52, v53
    v_mfma_f32_16x16x32_bf16 v[12:15], a[128:131], a[48:51], v[44:47]
    v_exp_f32 v54, v18
    v_mfma_f32_16x16x32_bf16 v[12:15], a[132:135], a[52:55], v[12:15]
    buffer_load_dwordx4 v78, s[4:7], s28 offen offset:2048 nt lds
    v_mfma_f32_16x16x32_bf16 v[12:15], a[136:139], a[56:59], v[12:15]
    v_exp_f32 v55, v19
    v_mfma_f32_16x16x32_bf16 v[12:15], a[140:143], a[60:63], v[12:15]
    ds_read_b128 a[108:111], v67 offset:4096
    v_cvt_pk_bf16_f32 v29, v54, v55
    v_mfma_f32_16x16x32_bf16 v[100:103], a[176:179], v[24:27], v[100:103]
    v_exp_f32 v52, v20
    v_mfma_f32_16x16x32_bf16 v[120:123], a[180:183], v[24:27], v[120:123]
    ds_read_b64_tr_b16 a[144:145], v68 offset:0
    v_mfma_f32_16x16x32_bf16 v[140:143], a[184:187], v[24:27], v[140:143]
    v_exp_f32 v53, v21
    v_mfma_f32_16x16x32_bf16 v[160:163], a[188:191], v[24:27], v[160:163]
    ds_read_b64_tr_b16 a[146:147], v68 offset:4096
    v_cvt_pk_bf16_f32 v30, v52, v53
    v_mfma_f32_16x16x32_bf16 v[180:183], a[192:195], v[24:27], v[180:183]
    v_exp_f32 v54, v22
    v_mfma_f32_16x16x32_bf16 v[200:203], a[196:199], v[24:27], v[200:203]
    ds_read_b64_tr_b16 a[148:149], v69 offset:0
    v_mfma_f32_16x16x32_bf16 v[220:223], a[200:203], v[24:27], v[220:223]
    v_exp_f32 v55, v23
    v_mfma_f32_16x16x32_bf16 v[240:243], a[204:207], v[24:27], v[240:243]
    v_cvt_pk_bf16_f32 v31, v54, v55
    v_mfma_f32_16x16x32_bf16 v[16:19], a[112:115], a[64:67], v[48:51]
    v_exp_f32 v52, v8
    v_smfmac_f32_16x16x64_bf16 a[220:223], a[228:231], v[24:31], v60
    ds_read_b64_tr_b16 a[150:151], v69 offset:4096
    v_mfma_f32_16x16x32_bf16 v[16:19], a[116:119], a[68:71], v[16:19]
    buffer_load_dwordx4 v79, s[4:7], s28 offen offset:3072 nt lds
    v_mfma_f32_16x16x32_bf16 v[16:19], a[120:123], a[72:75], v[16:19]
    v_exp_f32 v53, v9
    v_mfma_f32_16x16x32_bf16 v[16:19], a[124:127], a[76:79], v[16:19]
    ds_read_b64_tr_b16 a[152:153], v70 offset:0
    v_cvt_pk_bf16_f32 v24, v52, v53
    v_mfma_f32_16x16x32_bf16 v[20:23], a[128:131], a[64:67], v[48:51]
    v_exp_f32 v54, v10
    v_mfma_f32_16x16x32_bf16 v[20:23], a[132:135], a[68:71], v[20:23]
    ds_read_b64_tr_b16 a[154:155], v70 offset:4096
    v_mfma_f32_16x16x32_bf16 v[20:23], a[136:139], a[72:75], v[20:23]
    v_exp_f32 v55, v11
    v_mfma_f32_16x16x32_bf16 v[20:23], a[140:143], a[76:79], v[20:23]
    v_cvt_pk_bf16_f32 v25, v54, v55
    v_mfma_f32_16x16x32_bf16 v[104:107], a[176:179], v[28:31], v[104:107]
    s_add_u32 m0, s27, 114688
    v_exp_f32 v52, v12
    v_mfma_f32_16x16x32_bf16 v[124:127], a[180:183], v[28:31], v[124:127]
    buffer_load_dwordx4 v80, s[8:11], s28 offen offset:0 nt lds
    v_mfma_f32_16x16x32_bf16 v[144:147], a[184:187], v[28:31], v[144:147]
    v_exp_f32 v53, v13
    v_mfma_f32_16x16x32_bf16 v[164:167], a[188:191], v[28:31], v[164:167]
    ds_read_b64_tr_b16 a[156:157], v71 offset:0
    v_cvt_pk_bf16_f32 v26, v52, v53
    v_mfma_f32_16x16x32_bf16 v[184:187], a[192:195], v[28:31], v[184:187]
    v_exp_f32 v54, v14
    v_mfma_f32_16x16x32_bf16 v[204:207], a[196:199], v[28:31], v[204:207]
    ds_read_b64_tr_b16 a[158:159], v71 offset:4096
    v_mfma_f32_16x16x32_bf16 v[224:227], a[200:203], v[28:31], v[224:227]
    s_waitcnt lgkmcnt(8)
    v_exp_f32 v55, v15
    v_mfma_f32_16x16x32_bf16 v[244:247], a[204:207], v[28:31], v[244:247]
    ds_read_b64_tr_b16 a[160:161], v72 offset:0
    v_cvt_pk_bf16_f32 v27, v54, v55
    v_mfma_f32_16x16x32_bf16 v[8:11], a[80:83], a[0:3], v[32:35]
    v_exp_f32 v52, v16
    v_mfma_f32_16x16x32_bf16 v[8:11], a[84:87], a[4:7], v[8:11]
    ds_read_b64_tr_b16 a[162:163], v72 offset:4096
    v_mfma_f32_16x16x32_bf16 v[8:11], a[88:91], a[8:11], v[8:11]
    v_exp_f32 v53, v17
    v_mfma_f32_16x16x32_bf16 v[8:11], a[92:95], a[12:15], v[8:11]
    v_cvt_pk_bf16_f32 v28, v52, v53
    v_mfma_f32_16x16x32_bf16 v[12:15], a[96:99], a[0:3], v[32:35]
    v_exp_f32 v54, v18
    v_mfma_f32_16x16x32_bf16 v[12:15], a[100:103], a[4:7], v[12:15]
    buffer_load_dwordx4 v81, s[8:11], s28 offen offset:1024 nt lds
    v_mfma_f32_16x16x32_bf16 v[12:15], a[104:107], a[8:11], v[12:15]
    v_exp_f32 v55, v19
    v_mfma_f32_16x16x32_bf16 v[12:15], a[108:111], a[12:15], v[12:15]
    ds_read_b64_tr_b16 a[164:165], v73 offset:0
    v_cvt_pk_bf16_f32 v29, v54, v55
    v_mfma_f32_16x16x32_bf16 v[108:111], a[176:179], v[24:27], v[108:111]
    v_exp_f32 v52, v20
    v_mfma_f32_16x16x32_bf16 v[128:131], a[180:183], v[24:27], v[128:131]
    ds_read_b64_tr_b16 a[166:167], v73 offset:4096
    v_mfma_f32_16x16x32_bf16 v[148:151], a[184:187], v[24:27], v[148:151]
    v_exp_f32 v53, v21
    v_mfma_f32_16x16x32_bf16 v[168:171], a[188:191], v[24:27], v[168:171]
    ds_read_b64_tr_b16 a[168:169], v74 offset:0
    v_cvt_pk_bf16_f32 v30, v52, v53
    v_mfma_f32_16x16x32_bf16 v[188:191], a[192:195], v[24:27], v[188:191]
    v_exp_f32 v54, v22
    v_mfma_f32_16x16x32_bf16 v[208:211], a[196:199], v[24:27], v[208:211]
    buffer_load_dwordx4 v80, s[8:11], s28 offen offset:2048 nt lds
    v_mfma_f32_16x16x32_bf16 v[228:231], a[200:203], v[24:27], v[228:231]
    v_exp_f32 v55, v23
    v_mfma_f32_16x16x32_bf16 v[248:251], a[204:207], v[24:27], v[248:251]
    v_cvt_pk_bf16_f32 v31, v54, v55
    v_mfma_f32_16x16x32_bf16 v[16:19], a[80:83], a[16:19], v[36:39]
    v_exp_f32 v52, v8
    v_smfmac_f32_16x16x64_bf16 a[224:227], a[228:231], v[24:31], v60
    ds_read_b64_tr_b16 a[170:171], v74 offset:4096
    v_mfma_f32_16x16x32_bf16 v[16:19], a[84:87], a[20:23], v[16:19]
    ds_read_b64_tr_b16 a[172:173], v75 offset:0
    v_mfma_f32_16x16x32_bf16 v[16:19], a[88:91], a[24:27], v[16:19]
    v_exp_f32 v53, v9
    v_mfma_f32_16x16x32_bf16 v[16:19], a[92:95], a[28:31], v[16:19]
    ds_read_b64_tr_b16 a[174:175], v75 offset:4096
    v_cvt_pk_bf16_f32 v24, v52, v53
    v_mfma_f32_16x16x32_bf16 v[20:23], a[96:99], a[16:19], v[36:39]
    v_exp_f32 v54, v10
    v_mfma_f32_16x16x32_bf16 v[20:23], a[100:103], a[20:23], v[20:23]
    buffer_load_dwordx4 v81, s[8:11], s28 offen offset:3072 nt lds
    v_mfma_f32_16x16x32_bf16 v[20:23], a[104:107], a[24:27], v[20:23]
    s_add_u32 s28, s28, 16384
    v_exp_f32 v55, v11
    v_mfma_f32_16x16x32_bf16 v[20:23], a[108:111], a[28:31], v[20:23]
    v_cvt_pk_bf16_f32 v25, v54, v55
    v_mfma_f32_16x16x32_bf16 v[112:115], a[176:179], v[28:31], v[112:115]
    s_add_u32 s29, s29, 1
    v_exp_f32 v52, v12
    v_mfma_f32_16x16x32_bf16 v[132:135], a[180:183], v[28:31], v[132:135]
    v_mfma_f32_16x16x32_bf16 v[152:155], a[184:187], v[28:31], v[152:155]
    s_cmp_lt_u32 s29, 7
    v_exp_f32 v53, v13
    v_mfma_f32_16x16x32_bf16 v[172:175], a[188:191], v[28:31], v[172:175]
    v_cvt_pk_bf16_f32 v26, v52, v53
    v_mfma_f32_16x16x32_bf16 v[192:195], a[192:195], v[28:31], v[192:195]
    s_waitcnt vmcnt(16) lgkmcnt(0)
    v_exp_f32 v54, v14
    v_mfma_f32_16x16x32_bf16 v[212:215], a[196:199], v[28:31], v[212:215]
    s_barrier
    v_mfma_f32_16x16x32_bf16 v[232:235], a[200:203], v[28:31], v[232:235]
    v_exp_f32 v55, v15
    v_mfma_f32_16x16x32_bf16 v[252:255], a[204:207], v[28:31], v[252:255]
    v_cvt_pk_bf16_f32 v27, v54, v55
    s_cbranch_scc1 L_loop
    v_mfma_f32_16x16x32_bf16 v[8:11], a[80:83], a[32:35], v[40:43]
    s_add_u32 m0, s27, 131072
    s_xor_b32 s30, s33, 0
    v_exp_f32 v52, v16
    v_mfma_f32_16x16x32_bf16 v[8:11], a[84:87], a[36:39], v[8:11]
    buffer_load_dwordx4 v82, s[20:23], s30 offen offset:0 lds
    v_mfma_f32_16x16x32_bf16 v[8:11], a[88:91], a[40:43], v[8:11]
    v_exp_f32 v53, v17
    v_mfma_f32_16x16x32_bf16 v[8:11], a[92:95], a[44:47], v[8:11]
    ds_read_b128 a[112:115], v64 offset:16384
    v_cvt_pk_bf16_f32 v28, v52, v53
    v_mfma_f32_16x16x32_bf16 v[12:15], a[96:99], a[32:35], v[40:43]
    v_exp_f32 v54, v18
    v_mfma_f32_16x16x32_bf16 v[12:15], a[100:103], a[36:39], v[12:15]
    ds_read_b128 a[116:119], v65 offset:16384
    v_mfma_f32_16x16x32_bf16 v[12:15], a[104:107], a[40:43], v[12:15]
    v_exp_f32 v55, v19
    v_mfma_f32_16x16x32_bf16 v[12:15], a[108:111], a[44:47], v[12:15]
    ds_read_b128 a[120:123], v66 offset:16384
    v_cvt_pk_bf16_f32 v29, v54, v55
    v_mfma_f32_16x16x32_bf16 v[96:99], a[144:147], v[24:27], v[96:99]
    v_exp_f32 v52, v20
    v_mfma_f32_16x16x32_bf16 v[116:119], a[148:151], v[24:27], v[116:119]
    buffer_load_dwordx4 v83, s[20:23], s30 offen offset:1024 lds
    v_mfma_f32_16x16x32_bf16 v[136:139], a[152:155], v[24:27], v[136:139]
    v_exp_f32 v53, v21
    v_mfma_f32_16x16x32_bf16 v[156:159], a[156:159], v[24:27], v[156:159]
    ds_read_b128 a[124:127], v67 offset:16384
    v_cvt_pk_bf16_f32 v30, v52, v53
    v_mfma_f32_16x16x32_bf16 v[176:179], a[160:163], v[24:27], v[176:179]
    v_exp_f32 v54, v22
    v_mfma_f32_16x16x32_bf16 v[196:199], a[164:167], v[24:27], v[196:199]
    buffer_load_dwordx4 v84, s[20:23], s30 offen offset:2048 lds
    v_mfma_f32_16x16x32_bf16 v[216:219], a[168:171], v[24:27], v[216:219]
    v_exp_f32 v55, v23
    v_mfma_f32_16x16x32_bf16 v[236:239], a[172:175], v[24:27], v[236:239]
    ds_read_b128 a[128:131], v64 offset:20480
    v_cvt_pk_bf16_f32 v31, v54, v55
    v_mfma_f32_16x16x32_bf16 v[16:19], a[80:83], a[48:51], v[44:47]
    v_exp_f32 v52, v8
    v_smfmac_f32_16x16x64_bf16 a[208:211], a[228:231], v[24:31], v60
    ds_read_b128 a[132:135], v65 offset:20480
    v_mfma_f32_16x16x32_bf16 v[16:19], a[84:87], a[52:55], v[16:19]
    ds_read_b128 a[136:139], v66 offset:20480
    v_mfma_f32_16x16x32_bf16 v[16:19], a[88:91], a[56:59], v[16:19]
    v_exp_f32 v53, v9
    v_mfma_f32_16x16x32_bf16 v[16:19], a[92:95], a[60:63], v[16:19]
    v_cvt_pk_bf16_f32 v24, v52, v53
    v_add_u32 v76, 65536, v61
    v_mfma_f32_16x16x32_bf16 v[20:23], a[96:99], a[48:51], v[44:47]
    v_exp_f32 v54, v10
    v_mfma_f32_16x16x32_bf16 v[20:23], a[100:103], a[52:55], v[20:23]
    buffer_load_dwordx4 v85, s[20:23], s30 offen offset:3072 lds
    v_mfma_f32_16x16x32_bf16 v[20:23], a[104:107], a[56:59], v[20:23]
    v_exp_f32 v55, v11
    v_mfma_f32_16x16x32_bf16 v[20:23], a[108:111], a[60:63], v[20:23]
    ds_read_b128 a[140:143], v67 offset:20480
    v_cvt_pk_bf16_f32 v25, v54, v55
    v_mfma_f32_16x16x32_bf16 v[100:103], a[144:147], v[28:31], v[100:103]
    v_exp_f32 v52, v12
    v_mfma_f32_16x16x32_bf16 v[120:123], a[148:151], v[28:31], v[120:123]
    ds_read_b64_tr_b16 a[176:177], v68 offset:16384
    v_mfma_f32_16x16x32_bf16 v[140:143], a[152:155], v[28:31], v[140:143]
    v_exp_f32 v53, v13
    v_mfma_f32_16x16x32_bf16 v[160:163], a[156:159], v[28:31], v[160:163]
    s_xor_b32 s30, s33, 65536
    ds_read_b64_tr_b16 a[178:179], v68 offset:20480
    v_cvt_pk_bf16_f32 v26, v52, v53
    v_mfma_f32_16x16x32_bf16 v[180:183], a[160:163], v[28:31], v[180:183]
    s_add_u32 m0, s27, 147456
    v_exp_f32 v54, v14
    v_mfma_f32_16x16x32_bf16 v[200:203], a[164:167], v[28:31], v[200:203]
    buffer_load_dwordx4 v82, s[20:23], s30 offen offset:0 lds
    v_mfma_f32_16x16x32_bf16 v[220:223], a[168:171], v[28:31], v[220:223]
    v_exp_f32 v55, v15
    v_mfma_f32_16x16x32_bf16 v[240:243], a[172:175], v[28:31], v[240:243]
    ds_read_b64_tr_b16 a[180:181], v69 offset:16384
    v_cvt_pk_bf16_f32 v27, v54, v55
    v_mfma_f32_16x16x32_bf16 v[8:11], a[80:83], a[64:67], v[48:51]
    v_exp_f32 v52, v16
    v_mfma_f32_16x16x32_bf16 v[8:11], a[84:87], a[68:71], v[8:11]
    buffer_load_dwordx4 v83, s[20:23], s30 offen offset:1024 lds
    v_mfma_f32_16x16x32_bf16 v[8:11], a[88:91], a[72:75], v[8:11]
    v_exp_f32 v53, v17
    v_mfma_f32_16x16x32_bf16 v[8:11], a[92:95], a[76:79], v[8:11]
    ds_read_b64_tr_b16 a[182:183], v69 offset:20480
    v_cvt_pk_bf16_f32 v28, v52, v53
    v_mfma_f32_16x16x32_bf16 v[12:15], a[96:99], a[64:67], v[48:51]
    v_exp_f32 v54, v18
    v_mfma_f32_16x16x32_bf16 v[12:15], a[100:103], a[68:71], v[12:15]
    ds_read_b64_tr_b16 a[184:185], v70 offset:16384
    v_mfma_f32_16x16x32_bf16 v[12:15], a[104:107], a[72:75], v[12:15]
    v_exp_f32 v55, v19
    v_mfma_f32_16x16x32_bf16 v[12:15], a[108:111], a[76:79], v[12:15]
    ds_read_b64_tr_b16 a[186:187], v70 offset:20480
    v_cvt_pk_bf16_f32 v29, v54, v55
    v_mfma_f32_16x16x32_bf16 v[104:107], a[144:147], v[24:27], v[104:107]
    v_exp_f32 v52, v20
    v_mfma_f32_16x16x32_bf16 v[124:127], a[148:151], v[24:27], v[124:127]
    buffer_load_dwordx4 v84, s[20:23], s30 offen offset:2048 lds
    v_mfma_f32_16x16x32_bf16 v[144:147], a[152:155], v[24:27], v[144:147]
    v_exp_f32 v53, v21
    v_mfma_f32_16x16x32_bf16 v[164:167], a[156:159], v[24:27], v[164:167]
    ds_read_b64_tr_b16 a[188:189], v71 offset:16384
    v_cvt_pk_bf16_f32 v30, v52, v53
    v_mfma_f32_16x16x32_bf16 v[184:187], a[160:163], v[24:27], v[184:187]
    v_exp_f32 v54, v22
    v_mfma_f32_16x16x32_bf16 v[204:207], a[164:167], v[24:27], v[204:207]
    buffer_load_dwordx4 v85, s[20:23], s30 offen offset:3072 lds
    v_mfma_f32_16x16x32_bf16 v[224:227], a[168:171], v[24:27], v[224:227]
    s_waitcnt lgkmcnt(7)
    v_exp_f32 v55, v23
    v_mfma_f32_16x16x32_bf16 v[244:247], a[172:175], v[24:27], v[244:247]
    ds_read_b64_tr_b16 a[190:191], v71 offset:20480
    v_cvt_pk_bf16_f32 v31, v54, v55
    v_mfma_f32_16x16x32_bf16 v[16:19], a[112:115], a[0:3], v[32:35]
    v_exp_f32 v52, v8
    v_smfmac_f32_16x16x64_bf16 a[216:219], a[228:231], v[24:31], v60
    ds_read_b64_tr_b16 a[192:193], v72 offset:16384
    v_mfma_f32_16x16x32_bf16 v[16:19], a[116:119], a[4:7], v[16:19]
    ds_read_b64_tr_b16 a[194:195], v72 offset:20480
    v_mfma_f32_16x16x32_bf16 v[16:19], a[120:123], a[8:11], v[16:19]
    v_exp_f32 v53, v9
    v_mfma_f32_16x16x32_bf16 v[16:19], a[124:127], a[12:15], v[16:19]
    s_xor_b32 s30, s33, 131072
    v_cvt_pk_bf16_f32 v24, v52, v53
    v_add_u32 v77, 65536, v62
    v_mfma_f32_16x16x32_bf16 v[20:23], a[128:131], a[0:3], v[32:35]
    s_add_u32 m0, s27, 0
    v_exp_f32 v54, v10
    v_mfma_f32_16x16x32_bf16 v[20:23], a[132:135], a[4:7], v[20:23]
    buffer_load_dwordx4 v82, s[20:23], s30 offen offset:0 lds
    v_mfma_f32_16x16x32_bf16 v[20:23], a[136:139], a[8:11], v[20:23]
    v_exp_f32 v55, v11
    v_mfma_f32_16x16x32_bf16 v[20:23], a[140:143], a[12:15], v[20:23]
    ds_read_b64_tr_b16 a[196:197], v73 offset:16384
    v_cvt_pk_bf16_f32 v25, v54, v55
    v_mfma_f32_16x16x32_bf16 v[108:111], a[144:147], v[28:31], v[108:111]
    v_exp_f32 v52, v12
    v_mfma_f32_16x16x32_bf16 v[128:131], a[148:151], v[28:31], v[128:131]
    ds_read_b64_tr_b16 a[198:199], v73 offset:20480
    v_mfma_f32_16x16x32_bf16 v[148:151], a[152:155], v[28:31], v[148:151]
    v_exp_f32 v53, v13
    v_mfma_f32_16x16x32_bf16 v[168:171], a[156:159], v[28:31], v[168:171]
    ds_read_b64_tr_b16 a[200:201], v74 offset:16384
    v_cvt_pk_bf16_f32 v26, v52, v53
    v_mfma_f32_16x16x32_bf16 v[188:191], a[160:163], v[28:31], v[188:191]
    v_exp_f32 v54, v14
    v_mfma_f32_16x16x32_bf16 v[208:211], a[164:167], v[28:31], v[208:211]
    buffer_load_dwordx4 v83, s[20:23], s30 offen offset:1024 lds
    v_mfma_f32_16x16x32_bf16 v[228:231], a[168:171], v[28:31], v[228:231]
    v_exp_f32 v55, v15
    v_mfma_f32_16x16x32_bf16 v[248:251], a[172:175], v[28:31], v[248:251]
    ds_read_b64_tr_b16 a[202:203], v74 offset:20480
    v_cvt_pk_bf16_f32 v27, v54, v55
    v_mfma_f32_16x16x32_bf16 v[8:11], a[112:115], a[16:19], v[36:39]
    v_exp_f32 v52, v16
    v_mfma_f32_16x16x32_bf16 v[8:11], a[116:119], a[20:23], v[8:11]
    buffer_load_dwordx4 v84, s[20:23], s30 offen offset:2048 lds
    v_mfma_f32_16x16x32_bf16 v[8:11], a[120:123], a[24:27], v[8:11]
    v_exp_f32 v53, v17
    v_mfma_f32_16x16x32_bf16 v[8:11], a[124:127], a[28:31], v[8:11]
    ds_read_b64_tr_b16 a[204:205], v75 offset:16384
    v_cvt_pk_bf16_f32 v28, v52, v53
    v_mfma_f32_16x16x32_bf16 v[12:15], a[128:131], a[16:19], v[36:39]
    v_exp_f32 v54, v18
    v_mfma_f32_16x16x32_bf16 v[12:15], a[132:135], a[20:23], v[12:15]
    ds_read_b64_tr_b16 a[206:207], v75 offset:20480
    v_mfma_f32_16x16x32_bf16 v[12:15], a[136:139], a[24:27], v[12:15]
    v_exp_f32 v55, v19
    v_mfma_f32_16x16x32_bf16 v[12:15], a[140:143], a[28:31], v[12:15]
    v_cvt_pk_bf16_f32 v29, v54, v55
    v_add_u32 v78, 65536, v63
    v_mfma_f32_16x16x32_bf16 v[112:115], a[144:147], v[24:27], v[112:115]
    v_exp_f32 v52, v20
    v_mfma_f32_16x16x32_bf16 v[132:135], a[148:151], v[24:27], v[132:135]
    buffer_load_dwordx4 v85, s[20:23], s30 offen offset:3072 lds
    v_mfma_f32_16x16x32_bf16 v[152:155], a[152:155], v[24:27], v[152:155]
    v_exp_f32 v53, v21
    v_mfma_f32_16x16x32_bf16 v[172:175], a[156:159], v[24:27], v[172:175]
    v_cvt_pk_bf16_f32 v30, v52, v53
    v_add_u32 v79, 65536, v95
    v_mfma_f32_16x16x32_bf16 v[192:195], a[160:163], v[24:27], v[192:195]
    s_waitcnt vmcnt(20) lgkmcnt(0)
    v_exp_f32 v54, v22
    v_mfma_f32_16x16x32_bf16 v[212:215], a[164:167], v[24:27], v[212:215]
    s_barrier
    v_mfma_f32_16x16x32_bf16 v[232:235], a[168:171], v[24:27], v[232:235]
    v_exp_f32 v55, v23
    v_mfma_f32_16x16x32_bf16 v[252:255], a[172:175], v[24:27], v[252:255]
    v_cvt_pk_bf16_f32 v31, v54, v55
    v_mfma_f32_16x16x32_bf16 v[16:19], a[112:115], a[32:35], v[40:43]
    s_xor_b32 s30, s33, 196608
    v_exp_f32 v52, v8
    v_smfmac_f32_16x16x64_bf16 a[212:215], a[228:231], v[24:31], v60
    s_add_u32 m0, s27, 65536
    ds_read_b128 a[80:83], v64 offset:32768
    v_mfma_f32_16x16x32_bf16 v[16:19], a[116:119], a[36:39], v[16:19]
    buffer_load_dwordx4 v82, s[20:23], s30 offen offset:0 lds
    v_mfma_f32_16x16x32_bf16 v[16:19], a[120:123], a[40:43], v[16:19]
    v_exp_f32 v53, v9
    v_mfma_f32_16x16x32_bf16 v[16:19], a[124:127], a[44:47], v[16:19]
    ds_read_b128 a[84:87], v65 offset:32768
    v_cvt_pk_bf16_f32 v24, v52, v53
    v_mfma_f32_16x16x32_bf16 v[20:23], a[128:131], a[32:35], v[40:43]
    v_exp_f32 v54, v10
    v_mfma_f32_16x16x32_bf16 v[20:23], a[132:135], a[36:39], v[20:23]
    ds_read_b128 a[88:91], v66 offset:32768
    ds_read_b128 a[92:95], v67 offset:32768
    v_mfma_f32_16x16x32_bf16 v[20:23], a[136:139], a[40:43], v[20:23]
    v_exp_f32 v55, v11
    v_mfma_f32_16x16x32_bf16 v[20:23], a[140:143], a[44:47], v[20:23]
    ds_read_b128 a[96:99], v64 offset:36864
    v_cvt_pk_bf16_f32 v25, v54, v55
    v_mfma_f32_16x16x32_bf16 v[96:99], a[176:179], v[28:31], v[96:99]
    v_exp_f32 v52, v12
    v_mfma_f32_16x16x32_bf16 v[116:119], a[180:183], v[28:31], v[116:119]
    buffer_load_dwordx4 v83, s[20:23], s30 offen offset:1024 lds
    v_mfma_f32_16x16x32_bf16 v[136:139], a[184:187], v[28:31], v[136:139]
    v_exp_f32 v53, v13
    v_mfma_f32_16x16x32_bf16 v[156:159], a[188:191], v[28:31], v[156:159]
    ds_read_b128 a[100:103], v65 offset:36864
    v_cvt_pk_bf16_f32 v26, v52, v53
    v_mfma_f32_16x16x32_bf16 v[176:179], a[192:195], v[28:31], v[176:179]
    v_exp_f32 v54, v14
    v_mfma_f32_16x16x32_bf16 v[196:199], a[196:199], v[28:31], v[196:199]
    buffer_load_dwordx4 v84, s[20:23], s30 offen offset:2048 lds
    v_mfma_f32_16x16x32_bf16 v[216:219], a[200:203], v[28:31], v[216:219]
    v_exp_f32 v55, v15
    v_mfma_f32_16x16x32_bf16 v[236:239], a[204:207], v[28:31], v[236:239]
    ds_read_b128 a[104:107], v66 offset:36864
    v_cvt_pk_bf16_f32 v27, v54, v55
    v_mfma_f32_16x16x32_bf16 v[8:11], a[112:115], a[48:51], v[44:47]
    v_exp_f32 v52, v16
    v_mfma_f32_16x16x32_bf16 v[8:11], a[116:119], a[52:55], v[8:11]
    ds_read_b128 a[108:111], v67 offset:36864
    v_mfma_f32_16x16x32_bf16 v[8:11], a[120:123], a[56:59], v[8:11]
    v_exp_f32 v53, v17
    v_mfma_f32_16x16x32_bf16 v[8:11], a[124:127], a[60:63], v[8:11]
    ds_read_b64_tr_b16 a[144:145], v68 offset:32768
    v_cvt_pk_bf16_f32 v28, v52, v53
    v_mfma_f32_16x16x32_bf16 v[12:15], a[128:131], a[48:51], v[44:47]
    v_exp_f32 v54, v18
    v_mfma_f32_16x16x32_bf16 v[12:15], a[132:135], a[52:55], v[12:15]
    buffer_load_dwordx4 v85, s[20:23], s30 offen offset:3072 lds
    v_mfma_f32_16x16x32_bf16 v[12:15], a[136:139], a[56:59], v[12:15]
    v_exp_f32 v55, v19
    v_mfma_f32_16x16x32_bf16 v[12:15], a[140:143], a[60:63], v[12:15]
    ds_read_b64_tr_b16 a[146:147], v68 offset:36864
    v_cvt_pk_bf16_f32 v29, v54, v55
    v_mfma_f32_16x16x32_bf16 v[100:103], a[176:179], v[24:27], v[100:103]
    v_exp_f32 v52, v20
    v_mfma_f32_16x16x32_bf16 v[120:123], a[180:183], v[24:27], v[120:123]
    ds_read_b64_tr_b16 a[148:149], v69 offset:32768
    ds_read_b64_tr_b16 a[150:151], v69 offset:36864
    v_mfma_f32_16x16x32_bf16 v[140:143], a[184:187], v[24:27], v[140:143]
    v_exp_f32 v53, v21
    v_mfma_f32_16x16x32_bf16 v[160:163], a[188:191], v[24:27], v[160:163]
    s_xor_b32 s30, s37, 262144
    ds_read_b64_tr_b16 a[152:153], v70 offset:32768
    v_cvt_pk_bf16_f32 v30, v52, v53
    v_mfma_f32_16x16x32_bf16 v[180:183], a[192:195], v[24:27], v[180:183]
    s_add_u32 m0, s27, 16384
    v_exp_f32 v54, v22
    v_mfma_f32_16x16x32_bf16 v[200:203], a[196:199], v[24:27], v[200:203]
    buffer_load_dwordx4 v82, s[20:23], s30 offen offset:0 lds
    v_mfma_f32_16x16x32_bf16 v[220:223], a[200:203], v[24:27], v[220:223]
    v_exp_f32 v55, v23
    v_mfma_f32_16x16x32_bf16 v[240:243], a[204:207], v[24:27], v[240:243]
    ds_read_b64_tr_b16 a[154:155], v70 offset:36864
    v_cvt_pk_bf16_f32 v31, v54, v55
    v_mfma_f32_16x16x32_bf16 v[16:19], a[112:115], a[64:67], v[48:51]
    v_exp_f32 v52, v8
    v_smfmac_f32_16x16x64_bf16 a[220:223], a[228:231], v[24:31], v60
    ds_read_b64_tr_b16 a[156:157], v71 offset:32768
    v_mfma_f32_16x16x32_bf16 v[16:19], a[116:119], a[68:71], v[16:19]
    buffer_load_dwordx4 v83, s[20:23], s30 offen offset:1024 lds
    v_mfma_f32_16x16x32_bf16 v[16:19], a[120:123], a[72:75], v[16:19]
    v_exp_f32 v53, v9
    v_mfma_f32_16x16x32_bf16 v[16:19], a[124:127], a[76:79], v[16:19]
    ds_read_b64_tr_b16 a[158:159], v71 offset:36864
    v_cvt_pk_bf16_f32 v24, v52, v53
    v_mfma_f32_16x16x32_bf16 v[20:23], a[128:131], a[64:67], v[48:51]
    v_exp_f32 v54, v10
    v_mfma_f32_16x16x32_bf16 v[20:23], a[132:135], a[68:71], v[20:23]
    ds_read_b64_tr_b16 a[160:161], v72 offset:32768
    ds_read_b64_tr_b16 a[162:163], v72 offset:36864
    v_mfma_f32_16x16x32_bf16 v[20:23], a[136:139], a[72:75], v[20:23]
    v_exp_f32 v55, v11
    v_mfma_f32_16x16x32_bf16 v[20:23], a[140:143], a[76:79], v[20:23]
    ds_read_b64_tr_b16 a[164:165], v73 offset:32768
    v_cvt_pk_bf16_f32 v25, v54, v55
    v_mfma_f32_16x16x32_bf16 v[104:107], a[176:179], v[28:31], v[104:107]
    v_exp_f32 v52, v12
    v_mfma_f32_16x16x32_bf16 v[124:127], a[180:183], v[28:31], v[124:127]
    buffer_load_dwordx4 v84, s[20:23], s30 offen offset:2048 lds
    v_mfma_f32_16x16x32_bf16 v[144:147], a[184:187], v[28:31], v[144:147]
    v_exp_f32 v53, v13
    v_mfma_f32_16x16x32_bf16 v[164:167], a[188:191], v[28:31], v[164:167]
    ds_read_b64_tr_b16 a[166:167], v73 offset:36864
    v_cvt_pk_bf16_f32 v26, v52, v53
    v_mfma_f32_16x16x32_bf16 v[184:187], a[192:195], v[28:31], v[184:187]
    v_exp_f32 v54, v14
    v_mfma_f32_16x16x32_bf16 v[204:207], a[196:199], v[28:31], v[204:207]
    buffer_load_dwordx4 v85, s[20:23], s30 offen offset:3072 lds
    v_mfma_f32_16x16x32_bf16 v[224:227], a[200:203], v[28:31], v[224:227]
    s_waitcnt lgkmcnt(12)
    v_exp_f32 v55, v15
    v_mfma_f32_16x16x32_bf16 v[244:247], a[204:207], v[28:31], v[244:247]
    ds_read_b64_tr_b16 a[168:169], v74 offset:32768
    v_cvt_pk_bf16_f32 v27, v54, v55
    v_mfma_f32_16x16x32_bf16 v[8:11], a[80:83], a[0:3], v[32:35]
    v_exp_f32 v52, v16
    v_mfma_f32_16x16x32_bf16 v[8:11], a[84:87], a[4:7], v[8:11]
    ds_read_b64_tr_b16 a[170:171], v74 offset:36864
    v_mfma_f32_16x16x32_bf16 v[8:11], a[88:91], a[8:11], v[8:11]
    v_exp_f32 v53, v17
    v_mfma_f32_16x16x32_bf16 v[8:11], a[92:95], a[12:15], v[8:11]
    s_xor_b32 s30, s37, 327680
    ds_read_b64_tr_b16 a[172:173], v75 offset:32768
    v_cvt_pk_bf16_f32 v28, v52, v53
    v_mfma_f32_16x16x32_bf16 v[12:15], a[96:99], a[0:3], v[32:35]
    s_add_u32 m0, s27, 81920
    v_exp_f32 v54, v18
    v_mfma_f32_16x16x32_bf16 v[12:15], a[100:103], a[4:7], v[12:15]
    buffer_load_dwordx4 v82, s[20:23], s30 offen offset:0 lds
    v_mfma_f32_16x16x32_bf16 v[12:15], a[104:107], a[8:11], v[12:15]
    v_exp_f32 v55, v19
    v_mfma_f32_16x16x32_bf16 v[12:15], a[108:111], a[12:15], v[12:15]
    ds_read_b64_tr_b16 a[174:175], v75 offset:36864
    v_cvt_pk_bf16_f32 v29, v54, v55
    v_mfma_f32_16x16x32_bf16 v[108:111], a[176:179], v[24:27], v[108:111]
    s_waitcnt vmcnt(9)
    v_exp_f32 v52, v20
    v_mfma_f32_16x16x32_bf16 v[128:131], a[180:183], v[24:27], v[128:131]
    ds_read_b64_tr_b16 a[240:241], v86 offset:0
    ds_read_b64_tr_b16 a[242:243], v86 offset:2048
    v_mfma_f32_16x16x32_bf16 v[148:151], a[184:187], v[24:27], v[148:151]
    v_exp_f32 v53, v21
    v_mfma_f32_16x16x32_bf16 v[168:171], a[188:191], v[24:27], v[168:171]
    ds_read_b64_tr_b16 a[244:245], v87 offset:0
    v_cvt_pk_bf16_f32 v30, v52, v53
    v_mfma_f32_16x16x32_bf16 v[188:191], a[192:195], v[24:27], v[188:191]
    v_exp_f32 v54, v22
    v_mfma_f32_16x16x32_bf16 v[208:211], a[196:199], v[24:27], v[208:211]
    buffer_load_dwordx4 v83, s[20:23], s30 offen offset:1024 lds
    v_mfma_f32_16x16x32_bf16 v[228:231], a[200:203], v[24:27], v[228:231]
    v_exp_f32 v55, v23
    v_mfma_f32_16x16x32_bf16 v[248:251], a[204:207], v[24:27], v[248:251]
    ds_read_b64_tr_b16 a[246:247], v87 offset:2048
    v_cvt_pk_bf16_f32 v31, v54, v55
    v_mfma_f32_16x16x32_bf16 v[16:19], a[80:83], a[16:19], v[36:39]
    v_exp_f32 v52, v8
    v_smfmac_f32_16x16x64_bf16 a[224:227], a[228:231], v[24:31], v60
    ds_read_b64_tr_b16 a[248:249], v88 offset:0
    v_mfma_f32_16x16x32_bf16 v[16:19], a[84:87], a[20:23], v[16:19]
    buffer_load_dwordx4 v84, s[20:23], s30 offen offset:2048 lds
    v_mfma_f32_16x16x32_bf16 v[16:19], a[88:91], a[24:27], v[16:19]
    v_exp_f32 v53, v9
    v_mfma_f32_16x16x32_bf16 v[16:19], a[92:95], a[28:31], v[16:19]
    ds_read_b64_tr_b16 a[250:251], v88 offset:2048
    v_cvt_pk_bf16_f32 v24, v52, v53
    v_mfma_f32_16x16x32_bf16 v[20:23], a[96:99], a[16:19], v[36:39]
    v_exp_f32 v54, v10
    v_mfma_f32_16x16x32_bf16 v[20:23], a[100:103], a[20:23], v[20:23]
    ds_read_b64_tr_b16 a[252:253], v89 offset:0
    ds_read_b64_tr_b16 a[254:255], v89 offset:2048
    v_mfma_f32_16x16x32_bf16 v[20:23], a[104:107], a[24:27], v[20:23]
    v_exp_f32 v55, v11
    v_mfma_f32_16x16x32_bf16 v[20:23], a[108:111], a[28:31], v[20:23]
    v_cvt_pk_bf16_f32 v25, v54, v55
    v_mfma_f32_16x16x32_bf16 v[112:115], a[176:179], v[28:31], v[112:115]
    v_exp_f32 v52, v12
    v_mfma_f32_16x16x32_bf16 v[132:135], a[180:183], v[28:31], v[132:135]
    buffer_load_dwordx4 v85, s[20:23], s30 offen offset:3072 lds
    v_mfma_f32_16x16x32_bf16 v[152:155], a[184:187], v[28:31], v[152:155]
    v_exp_f32 v53, v13
    v_mfma_f32_16x16x32_bf16 v[172:175], a[188:191], v[28:31], v[172:175]
    v_cvt_pk_bf16_f32 v26, v52, v53
    v_mfma_f32_16x16x32_bf16 v[192:195], a[192:195], v[28:31], v[192:195]
    s_waitcnt vmcnt(24) lgkmcnt(0)
    v_exp_f32 v54, v14
    v_mfma_f32_16x16x32_bf16 v[212:215], a[196:199], v[28:31], v[212:215]
    s_barrier
    v_mfma_f32_16x16x32_bf16 v[232:235], a[200:203], v[28:31], v[232:235]
    v_exp_f32 v55, v15
    v_mfma_f32_16x16x32_bf16 v[252:255], a[204:207], v[28:31], v[252:255]
    v_cvt_pk_bf16_f32 v27, v54, v55
    ds_read_b128 a[112:115], v64 offset:49152
    s_nop 0
    v_mfma_f32_16x16x32_bf16 v[156:159], a[156:159], v[24:27], v[156:159]
    s_add_u32 m0, s27, 32768
    ds_read_b128 a[116:119], v65 offset:49152
    v_accvgpr_read_b32 v3, a215
    v_mfma_f32_16x16x32_bf16 v[116:119], a[148:151], v[24:27], v[116:119]
    s_xor_b32 s30, s37, 393216
    ds_read_b128 a[128:131], v64 offset:53248
    buffer_load_dwordx4 v82, s[20:23], s30 offen offset:0 lds
    ds_read_b128 a[120:123], v66 offset:49152
    v_mfma_f32_16x16x32_bf16 v[236:239], a[172:175], v[24:27], v[236:239]
    ds_read_b128 a[132:135], v65 offset:53248
    v_exp_f32 v52, v16
    v_mfma_f32_16x16x32_bf16 v[176:179], a[160:163], v[24:27], v[176:179]
    ds_read_b64_tr_b16 a[196:197], v73 offset:49152
    v_exp_f32 v55, v19
    v_mfma_f32_16x16x32_bf16 v[136:139], a[152:155], v[24:27], v[136:139]
    ds_read_b128 a[136:139], v66 offset:53248
    buffer_load_dwordx4 v83, s[20:23], s30 offen offset:1024 lds
    ds_read_b128 a[124:127], v67 offset:49152
    v_exp_f32 v54, v18
    v_mfma_f32_16x16x32_bf16 v[216:219], a[168:171], v[24:27], v[216:219]
    ds_read_b64_tr_b16 a[182:183], v69 offset:53248
    v_exp_f32 v53, v17
    v_mfma_f32_16x16x32_bf16 v[196:199], a[164:167], v[24:27], v[196:199]
    v_cvt_pk_bf16_f32 v28, v52, v53
    v_cvt_pk_bf16_f32 v29, v54, v55
    v_mfma_f32_16x16x32_bf16 v[96:99], a[144:147], v[24:27], v[96:99]
    s_waitcnt lgkmcnt(8)
    ds_read_b128 a[140:143], v67 offset:53248
    buffer_load_dwordx4 v85, s[20:23], s30 offen offset:3072 lds
    ds_read_b64_tr_b16 a[202:203], v74 offset:53248
    v_mfma_f32_16x16x32_bf16 v[8:11], a[112:115], a[0:3], v[32:35]
    s_mul_i32 s8, s26, 12288
    v_exp_f32 v52, v20
    v_exp_f32 v55, v23
    v_mfma_f32_16x16x32_bf16 v[16:19], a[112:115], a[16:19], v[36:39]
    s_waitcnt lgkmcnt(7)
    ds_read_b64_tr_b16 a[180:181], v69 offset:49152
    v_accvgpr_read_b32 v56, a214
    v_mfma_f32_16x16x32_bf16 v[8:11], a[116:119], a[4:7], v[8:11]
    s_mov_b32 s18, 25165824
    ds_read_b64_tr_b16 a[186:187], v70 offset:53248
    buffer_load_dwordx4 v84, s[20:23], s30 offen offset:2048 lds
    v_mfma_f32_16x16x32_bf16 v[8:11], a[120:123], a[8:11], v[8:11]
    s_xor_b32 s30, s37, 458752
    ds_read_b64_tr_b16 a[188:189], v71 offset:49152
    v_exp_f32 v54, v22
    v_exp_f32 v53, v21
    v_mfma_f32_16x16x32_bf16 v[12:15], a[128:131], a[0:3], v[32:35]
    s_waitcnt lgkmcnt(6)
    v_accvgpr_read_b32 v57, a220
    v_accvgpr_read_b32 v7, a221
    v_mfma_f32_16x16x32_bf16 v[12:15], a[132:135], a[4:7], v[12:15]
    s_add_u32 m0, s27, 98304
    ds_read_b64_tr_b16 a[4:5], v77 offset:0
    buffer_load_dwordx4 v85, s[20:23], s30 offen offset:3072 lds
    ds_read_b64_tr_b16 a[200:201], v74 offset:49152
    v_accvgpr_mov_b32 a220, a216
    v_mfma_f32_16x16x32_bf16 v[16:19], a[116:119], a[20:23], v[16:19]
    ds_read_b64_tr_b16 a[206:207], v75 offset:53248
    v_cvt_pk_bf16_f32 v30, v52, v53
    v_mfma_f32_16x16x32_bf16 v[8:11], a[124:127], a[12:15], v[8:11]
    s_add_u32 s4, s24, s58
    s_addc_u32 s5, s25, 0
    ds_read_b64_tr_b16 a[198:199], v73 offset:53248
    v_cvt_pk_bf16_f32 v31, v54, v55
    v_mfma_f32_16x16x32_bf16 v[12:15], a[136:139], a[8:11], v[12:15]
    ds_read_b64_tr_b16 a[192:193], v72 offset:49152
    buffer_load_dwordx4 v83, s[20:23], s30 offen offset:1024 lds
    v_mfma_f32_16x16x32_bf16 v[200:203], a[164:167], v[28:31], v[200:203]
    s_xor_b32 s97, s2, 16
    ds_read_b64_tr_b16 a[194:195], v72 offset:53248
    v_exp_f32 v54, v10
    v_exp_f32 v52, v8
    v_mfma_f32_16x16x32_bf16 v[16:19], a[120:123], a[24:27], v[16:19]
    s_waitcnt lgkmcnt(6)
    v_exp_f32 v55, v11
    v_mfma_f32_16x16x32_bf16 v[12:15], a[140:143], a[12:15], v[12:15]
    ds_read_b64_tr_b16 a[184:185], v70 offset:49152
    buffer_load_dwordx4 v82, s[20:23], s30 offen offset:0 lds
    ds_read_b64_tr_b16 a[2:3], v76 offset:2048
    v_smfmac_f32_16x16x64_bf16 a[208:211], a[228:231], v[24:31], v60
    ds_read_b64_tr_b16 a[10:11], v78 offset:2048
    v_mfma_f32_16x16x32_bf16 v[240:243], a[172:175], v[28:31], v[240:243]
    ds_read_b64_tr_b16 a[14:15], v79 offset:2048
    v_exp_f32 v53, v9
    v_mfma_f32_16x16x32_bf16 v[180:183], a[160:163], v[28:31], v[180:183]
    s_xor_b32 s96, s2, 8
    ds_read_b64_tr_b16 a[176:177], v68 offset:49152
    v_cvt_pk_bf16_f32 v24, v52, v53
    v_mfma_f32_16x16x32_bf16 v[20:23], a[128:131], a[16:19], v[36:39]
    buffer_load_dwordx4 v84, s[20:23], s30 offen offset:2048 lds
    v_mfma_f32_16x16x32_bf16 v[20:23], a[132:135], a[20:23], v[20:23]
    s_add_u32 m0, s27, 0
    ds_read_b64_tr_b16 a[12:13], v79 offset:0
    v_lshlrev_b32 v64, 4, v0
    v_mfma_f32_16x16x32_bf16 v[20:23], a[136:139], a[24:27], v[20:23]
    s_lshl2_add_u32 s97, s97, s26
    v_exp_f32 v52, v12
    v_mfma_f32_16x16x32_bf16 v[140:143], a[152:155], v[28:31], v[140:143]
    s_xor_b32 s30, s37, 589824
    ds_read_b64_tr_b16 a[18:19], v76 offset:18432
    v_cvt_pk_bf16_f32 v25, v54, v55
    v_mfma_f32_16x16x32_bf16 v[8:11], a[80:83], a[32:35], v[40:43]
    ds_read_b64_tr_b16 a[204:205], v75 offset:49152
    buffer_load_dwordx4 v83, s[20:23], s30 offen offset:1024 lds
    ds_read_b64_tr_b16 a[178:179], v68 offset:53248
    v_mfma_f32_16x16x32_bf16 v[120:123], a[148:151], v[28:31], v[120:123]
    ds_read_b64_tr_b16 a[190:191], v71 offset:53248
    v_exp_f32 v55, v15
    v_exp_f32 v53, v13
    v_mfma_f32_16x16x32_bf16 v[16:19], a[124:127], a[28:31], v[16:19]
    s_lshl2_add_u32 s96, s96, s26
    ds_read_b64_tr_b16 a[22:23], v77 offset:18432
    v_add_f32 v56, v56, v3
    v_mfma_f32_16x16x32_bf16 v[220:223], a[168:171], v[28:31], v[220:223]
    buffer_load_dwordx4 v84, s[20:23], s30 offen offset:2048 lds
    v_mfma_f32_16x16x32_bf16 v[160:163], a[156:159], v[28:31], v[160:163]
    s_mul_i32 s97, s97, 10240
    v_exp_f32 v54, v14
    v_mfma_f32_16x16x32_bf16 v[8:11], a[84:87], a[36:39], v[8:11]
    ds_read_b64_tr_b16 a[6:7], v77 offset:2048
    v_cvt_pk_bf16_f32 v26, v52, v53
    v_mfma_f32_16x16x32_bf16 v[20:23], a[140:143], a[28:31], v[20:23]
    s_barrier
    v_mfma_f32_16x16x32_bf16 v[8:11], a[88:91], a[40:43], v[8:11]
    ds_read_b64_tr_b16 a[30:31], v79 offset:18432
    buffer_load_dwordx4 v85, s[20:23], s30 offen offset:3072 lds
    ds_read_b64_tr_b16 a[8:9], v78 offset:0
    v_exp_f32 v53, v17
    v_cvt_pk_bf16_f32 v27, v54, v55
    v_mfma_f32_16x16x32_bf16 v[100:103], a[144:147], v[28:31], v[100:103]
    s_waitcnt lgkmcnt(5)
    ds_read_b64_tr_b16 a[26:27], v78 offset:18432
    v_exp_f32 v52, v16
    v_exp_f32 v54, v18
    v_cvt_pk_bf16_f32 v28, v52, v53
    v_mfma_f32_16x16x32_bf16 v[236:239], a[204:207], v[24:27], v[236:239]
    ds_read_b64_tr_b16 a[24:25], v78 offset:16384
    buffer_load_dwordx4 v82, s[20:23], s30 offen offset:0 lds
    v_mfma_f32_16x16x32_bf16 v[216:219], a[200:203], v[24:27], v[216:219]
    s_add_u32 m0, s27, 49152
    ds_read_b64_tr_b16 a[16:17], v76 offset:16384
    v_exp_f32 v55, v19
    v_mfma_f32_16x16x32_bf16 v[8:11], a[92:95], a[44:47], v[8:11]
    ds_read_b64_tr_b16 a[0:1], v76 offset:0
    v_cvt_pk_bf16_f32 v29, v54, v55
    v_mfma_f32_16x16x32_bf16 v[196:199], a[196:199], v[24:27], v[196:199]
    ds_read_b64_tr_b16 a[28:29], v79 offset:16384
    v_exp_f32 v54, v22
    v_mfma_f32_16x16x32_bf16 v[12:15], a[96:99], a[32:35], v[40:43]
    v_exp_f32 v53, v21
    v_add_f32 v57, v57, v7
    v_mfma_f32_16x16x32_bf16 v[176:179], a[192:195], v[24:27], v[176:179]
    v_exp_f32 v52, v20
    v_exp_f32 v55, v23
    v_cvt_pk_bf16_f32 v216, v216, v217
    v_mfma_f32_16x16x32_bf16 v[16:19], a[112:115], a[32:35], v[40:43]
    s_xor_b32 s30, s37, 524288
    ds_read_b64_tr_b16 a[20:21], v77 offset:16384
    buffer_load_dwordx4 v82, s[20:23], s30 offen offset:0 lds
    v_cvt_pk_bf16_f32 v217, v218, v219
    v_mfma_f32_16x16x32_bf16 v[20:23], a[128:131], a[32:35], v[40:43]
    v_cvt_pk_bf16_f32 v30, v52, v53
    v_cvt_pk_bf16_f32 v31, v54, v55
    v_exp_f32 v53, v9
    v_cvt_pk_bf16_f32 v176, v176, v177
    v_smfmac_f32_16x16x64_bf16 a[208:211], a[228:231], v[24:31], v60
    v_exp_f32 v54, v10
    v_mfma_f32_16x16x32_bf16 v[180:183], a[192:195], v[28:31], v[180:183]
    s_mov_b32 s6, 64
    v_exp_f32 v52, v8
    v_cvt_pk_bf16_f32 v177, v178, v179
    v_mfma_f32_16x16x32_bf16 v[240:243], a[204:207], v[28:31], v[240:243]
    buffer_load_dwordx4 v84, s[20:23], s30 offen offset:2048 lds
    v_mfma_f32_16x16x32_bf16 v[220:223], a[200:203], v[28:31], v[220:223]
    s_mov_b32 s16, s24
    v_accvgpr_read_b32 v3, a208
    v_accvgpr_read_b32 v7, a209
    v_mfma_f32_16x16x32_bf16 v[96:99], a[176:179], v[24:27], v[96:99]
    v_cvt_pk_bf16_f32 v178, v196, v197
    v_cvt_pk_bf16_f32 v218, v236, v237
    v_add_f32 v56, v56, v3
    v_exp_f32 v55, v11
    v_mfma_f32_16x16x32_bf16 v[12:15], a[100:103], a[36:39], v[12:15]
    s_waitcnt vmcnt(22)
    ds_read_b64_tr_b16 a[32:33], v61 offset:0
    v_cvt_pk_bf16_f32 v219, v238, v239
    v_cvt_pk_bf16_f32 v179, v198, v199
    v_mfma_f32_16x16x32_bf16 v[16:19], a[116:119], a[36:39], v[16:19]
    s_waitcnt lgkmcnt(1)
    v_add_f32 v56, v56, v7
    v_accvgpr_read_b32 v7, a211
    v_mfma_f32_16x16x32_bf16 v[136:139], a[184:187], v[24:27], v[136:139]
    s_barrier
    buffer_load_dwordx4 v85, s[20:23], s30 offen offset:3072 lds
    v_mfma_f32_16x16x32_bf16 v[12:15], a[104:107], a[40:43], v[12:15]
    s_xor_b32 s99, s2, s26
    ds_write_b32 v91, v56 offset:10240
    ds_write_b128 v91, v[216:219] offset:5120
    v_mfma_f32_16x16x32_bf16 v[12:15], a[108:111], a[44:47], v[12:15]
    v_cvt_pk_bf16_f32 v220, v220, v221
    v_cvt_pk_bf16_f32 v180, v180, v181
    v_accvgpr_mov_b32 a215, a227
    v_mfma_f32_16x16x32_bf16 v[200:203], a[196:199], v[28:31], v[200:203]
    buffer_load_dwordx4 v83, s[20:23], s30 offen offset:1024 lds
    v_mfma_f32_16x16x32_bf16 v[116:119], a[180:183], v[24:27], v[116:119]
    ds_write_b128 v91, v[176:179] offset:0
    v_cvt_pk_bf16_f32 v221, v222, v223
    v_mfma_f32_16x16x32_bf16 v[156:159], a[188:191], v[24:27], v[156:159]
    v_cvt_pk_bf16_f32 v24, v52, v53
    v_cvt_pk_bf16_f32 v25, v54, v55
    v_cvt_pk_bf16_f32 v222, v240, v241
    v_exp_f32 v52, v12
    v_accvgpr_read_b32 v3, a210
    v_mfma_f32_16x16x32_bf16 v[20:23], a[132:135], a[36:39], v[20:23]
    s_add_u32 m0, s27, 65536
    v_cvt_pk_bf16_f32 v223, v242, v243
    v_exp_f32 v54, v14
    v_exp_f32 v53, v13
    v_mfma_f32_16x16x32_bf16 v[8:11], a[80:83], a[48:51], v[44:47]
    ds_write_b128 v91, v[220:223] offset:6144
    v_mfma_f32_16x16x32_bf16 v[100:103], a[176:179], v[28:31], v[100:103]
    v_exp_f32 v55, v15
    v_cvt_pk_bf16_f32 v181, v182, v183
    v_mfma_f32_16x16x32_bf16 v[12:15], a[96:99], a[48:51], v[44:47]
    s_mov_b32 s19, 0x20000
    ds_read_b64_tr_b16 a[36:37], v62 offset:0
    v_cvt_pk_bf16_f32 v182, v200, v201
    v_mfma_f32_16x16x32_bf16 v[16:19], a[120:123], a[40:43], v[16:19]
    s_waitcnt lgkmcnt(2)
    ds_read_b64_tr_b16 a[38:39], v62 offset:2048
    v_mov_b32 v4, v56
    v_mfma_f32_16x16x32_bf16 v[16:19], a[124:127], a[44:47], v[16:19]
    s_barrier
    ds_read_b32 v5, v90 offset:10240
    v_mfma_f32_16x16x32_bf16 v[140:143], a[184:187], v[28:31], v[140:143]
    s_xor_b32 s30, s37, 655360
    ds_read_b128 v[36:39], v90 offset:5120
    v_add_f32 v57, v57, v3
    v_mfma_f32_16x16x32_bf16 v[8:11], a[84:87], a[52:55], v[8:11]
    ds_read_b128 v[32:35], v90 offset:0
    v_cvt_pk_bf16_f32 v183, v202, v203
    v_cvt_pk_bf16_f32 v27, v54, v55
    v_mfma_f32_16x16x32_bf16 v[120:123], a[180:183], v[28:31], v[120:123]
    ds_write_b128 v91, v[180:183] offset:1024
    v_mfma_f32_16x16x32_bf16 v[8:11], a[88:91], a[56:59], v[8:11]
    s_lshl_b32 s29, 0x1110, s26
    v_exp_f32 v55, v19
    v_add_f32 v57, v57, v7
    v_mfma_f32_16x16x32_bf16 v[20:23], a[136:139], a[40:43], v[20:23]
    ds_write_b32 v91, v57 offset:10244
    ds_read_b64_tr_b16 a[34:35], v61 offset:2048
    v_exp_f32 v54, v18
    v_cvt_pk_bf16_f32 v26, v52, v53
    v_mfma_f32_16x16x32_bf16 v[20:23], a[140:143], a[44:47], v[20:23]
    s_xor_b32 s98, s2, 24
    ds_read_b64_tr_b16 a[40:41], v63 offset:0
    v_accvgpr_mov_b32 a216, a224
    v_mfma_f32_16x16x32_bf16 v[224:227], a[168:171], v[24:27], v[224:227]
    ds_read_b64_tr_b16 a[42:43], v63 offset:2048
    v_accvgpr_mov_b32 a221, a217
    v_exp_f32 v52, v16
    v_exp_f32 v53, v17
    v_max_u32 v4, v4, v57
    v_mfma_f32_16x16x32_bf16 v[160:163], a[188:191], v[28:31], v[160:163]
    s_waitcnt lgkmcnt(6)
    ds_read_b64_tr_b16 a[44:45], v95 offset:0
    v_cvt_pk_bf16_f32 v28, v52, v53
    v_mfma_f32_16x16x32_bf16 v[156:159], a[232:235], v[36:39], v[156:159]
    ds_read_b64_tr_b16 a[46:47], v95 offset:2048
    v_cvt_pk_bf16_f32 v29, v54, v55
    v_add_f32 v56, v56, v5
    v_cmp_nge_f32 vcc, s38, v56
    v_exp_f32 v52, v20
    v_exp_f32 v55, v23
    v_mfma_f32_16x16x32_bf16 v[136:139], a[234:237], v[36:39], v[136:139]
    s_waitcnt vmcnt(20) lgkmcnt(7)
    ds_read_b64_tr_b16 v[178:179], v86 offset:18432
    v_rcp_f32 v56, v56
    v_mfma_f32_16x16x32_bf16 v[116:119], a[232:235], v[32:35], v[116:119]
    s_waitcnt vmcnt(16) lgkmcnt(6)
    ds_read_b64_tr_b16 v[220:221], v62 offset:16384
    v_and_b32 v76, 3, v0
    v_mfma_f32_16x16x32_bf16 v[96:99], a[234:237], v[32:35], v[96:99]
    s_barrier
    v_mul_f32 v138, v56, v138
    v_accvgpr_mov_b32 a214, a226
    v_exp_f32 v54, v22
    v_mul_f32 v159, v56, v159
    v_mul_f32 v137, v56, v137
    v_mul_f32 v156, v56, v156
    v_exp_f32 v53, v21
    v_mul_f32 v136, v56, v136
    v_mfma_f32_16x16x32_bf16 v[12:15], a[100:103], a[52:55], v[12:15]
    s_mov_b32 s17, s25
    ds_read_b64_tr_b16 v[216:217], v87 offset:16384
    v_cvt_pk_bf16_f32 v136, v136, v137
    v_mfma_f32_16x16x32_bf16 v[204:207], a[164:167], v[24:27], v[204:207]
    s_waitcnt lgkmcnt(3)
    ds_read_b64_tr_b16 v[218:219], v87 offset:18432
    buffer_load_dwordx4 v82, s[20:23], s30 offen offset:0 lds
    v_cvt_pk_bf16_f32 v31, v54, v55
    v_mul_f32 v158, v56, v158
    v_mul_f32 v99, v56, v99
    v_mul_f32 v139, v56, v139
    v_cvt_pk_bf16_f32 v137, v138, v139
    v_mul_f32 v96, v56, v96
    v_mul_f32 v119, v56, v119
    v_mfma_f32_16x16x32_bf16 v[184:187], a[160:163], v[24:27], v[184:187]
    ds_read_b128 v[32:35], v90 offset:1024
    v_mul_f32 v118, v56, v118
    v_cvt_pk_bf16_f32 v30, v52, v53
    v_mfma_f32_16x16x32_bf16 v[20:23], a[128:131], a[48:51], v[44:47]
    buffer_load_dwordx4 v83, s[20:23], s30 offen offset:1024 lds
    ds_read_b32 v6, v90 offset:10244
    v_mul_f32 v157, v56, v157
    v_mul_f32 v97, v56, v97
    v_mfma_f32_16x16x32_bf16 v[16:19], a[112:115], a[48:51], v[44:47]
    ds_read_b128 v[36:39], v90 offset:6144
    v_cvt_pk_bf16_f32 v139, v158, v159
    v_mul_f32 v116, v56, v116
    v_cvt_pk_bf16_f32 v138, v156, v157
    v_mul_f32 v117, v56, v117
    v_mul_f32 v98, v56, v98
    v_mfma_f32_16x16x32_bf16 v[184:187], a[192:195], v[28:31], v[184:187]
    buffer_store_dwordx4 v[136:139], v64, s[16:19], s56 offen offset:1024 sc0 sc1
    v_cvt_pk_bf16_f32 v96, v96, v97
    v_mfma_f32_16x16x32_bf16 v[224:227], a[200:203], v[28:31], v[224:227]
    v_cvt_pk_bf16_f32 v97, v98, v99
    v_cvt_pk_bf16_f32 v99, v118, v119
    v_cvt_pk_bf16_f32 v98, v116, v117
    v_smfmac_f32_16x16x64_bf16 a[220:223], a[228:231], v[24:31], v60
    ds_read_b64_tr_b16 v[176:177], v86 offset:16384
    buffer_store_dwordx4 v[96:99], v64, s[16:19], s56 offen offset:0 sc0 sc1
    ds_read_b64_tr_b16 v[156:157], v89 offset:16384
    v_mfma_f32_16x16x32_bf16 v[124:127], a[148:151], v[24:27], v[124:127]
    s_cmp_eq_u64 vcc, 0
    s_cselect_b64 s[44:45], 14, s[54:55]
    ds_read_b64_tr_b16 v[158:159], v89 offset:18432
    v_mfma_f32_16x16x32_bf16 v[8:11], a[92:95], a[60:63], v[8:11]
    s_waitcnt lgkmcnt(5)
    ds_read_b64_tr_b16 v[118:119], v88 offset:18432
    buffer_load_dwordx4 v85, s[20:23], s30 offen offset:3072 lds
    ds_read_b64_tr_b16 v[116:117], v88 offset:16384
    v_cvt_pk_bf16_f32 v184, v184, v185
    v_mfma_f32_16x16x32_bf16 v[100:103], a[234:237], v[32:35], v[100:103]
    s_waitcnt lgkmcnt(5)
    ds_read_b64_tr_b16 v[180:181], v61 offset:16384
    v_add_f32 v57, v57, v6
    v_lshlrev_b32 v77, 3, v76
    v_mfma_f32_16x16x32_bf16 v[140:143], a[234:237], v[36:39], v[140:143]
    ds_write_b128 v90, v[136:139] offset:5120
    buffer_load_dwordx4 v84, s[20:23], s30 offen offset:2048 lds
    v_mfma_f32_16x16x32_bf16 v[120:123], a[232:235], v[32:35], v[120:123]
    s_add_u32 m0, s27, 16384
    v_cmp_nge_f32 vcc, s38, v57
    v_cvt_pk_bf16_f32 v185, v186, v187
    v_rcp_f32 v57, v57
    v_mfma_f32_16x16x32_bf16 v[244:247], a[172:175], v[24:27], v[244:247]
    s_mul_i32 s96, s96, 10240
    ds_write_b128 v90, v[96:99] offset:0
    v_mfma_f32_16x16x32_bf16 v[160:163], a[232:235], v[36:39], v[160:163]
    v_mul_f32 v121, v57, v121
    v_accvgpr_read_b32 v58, a220
    v_mfma_f32_16x16x32_bf16 v[16:19], a[116:119], a[52:55], v[16:19]
    s_lshl_b32 s99, s99, 7
    v_mul_f32 v102, v57, v102
    v_mul_f32 v122, v57, v122
    v_mfma_f32_16x16x32_bf16 v[20:23], a[132:135], a[52:55], v[20:23]
    s_xor_b32 s30, s37, 720896
    v_mul_f32 v160, v57, v160
    v_accvgpr_read_b32 v94, a223
    v_cvt_pk_bf16_f32 v224, v224, v225
    v_mul_f32 v101, v57, v101
    v_mfma_f32_16x16x32_bf16 v[204:207], a[196:199], v[28:31], v[204:207]
    s_waitcnt vmcnt(18) lgkmcnt(2)
    ds_read_b64_tr_b16 a[52:53], v87 offset:32768
    buffer_load_dwordx4 v84, s[20:23], s30 offen offset:2048 lds
    v_mul_f32 v120, v57, v120
    v_mul_f32 v161, v57, v161
    v_cvt_pk_bf16_f32 v225, v226, v227
    v_mul_f32 v162, v57, v162
    v_mul_f32 v100, v57, v100
    v_mul_f32 v103, v57, v103
    v_accvgpr_read_b32 v7, a222
    v_mul_f32 v123, v57, v123
    v_cvt_pk_bf16_f32 v100, v100, v101
    v_mul_f32 v143, v57, v143
    v_mfma_f32_16x16x32_bf16 v[244:247], a[204:207], v[28:31], v[244:247]
    v_accvgpr_read_b32 v3, a221
    v_cvt_pk_bf16_f32 v101, v102, v103
    v_mul_f32 v140, v57, v140
    v_cvt_pk_bf16_f32 v103, v122, v123
    v_cvt_pk_bf16_f32 v102, v120, v121
    v_mul_f32 v142, v57, v142
    v_mfma_f32_16x16x32_bf16 v[16:19], a[120:123], a[56:59], v[16:19]
    buffer_load_dwordx4 v83, s[20:23], s30 offen offset:1024 lds
    ds_write_b128 v90, v[100:103] offset:1024
    buffer_store_dwordx4 v[100:103], v64, s[16:19], s56 offen offset:2048 sc0 sc1
    v_exp_f32 v54, v10
    v_mul_f32 v141, v57, v141
    v_cvt_pk_bf16_f32 v186, v204, v205
    v_exp_f32 v55, v11
    v_cvt_pk_bf16_f32 v226, v244, v245
    v_cvt_pk_bf16_f32 v227, v246, v247
    v_add_f32 v58, v58, v3
    v_cvt_pk_bf16_f32 v140, v140, v141
    v_mfma_f32_16x16x32_bf16 v[236:239], a[4:7], v[96:99], 0
    ds_write_b128 v91, v[224:227] offset:7168
    v_cvt_pk_bf16_f32 v141, v142, v143
    v_mul_f32 v163, v57, v163
    v_cvt_pk_bf16_f32 v142, v160, v161
    v_cvt_pk_bf16_f32 v143, v162, v163
    v_cvt_pk_bf16_f32 v187, v206, v207
    v_mfma_f32_16x16x32_bf16 v[20:23], a[136:139], a[56:59], v[20:23]
    ds_read_b64_tr_b16 v[160:161], v95 offset:16384
    buffer_store_dwordx4 v[140:143], v64, s[16:19], s56 offen offset:3072 sc0 sc1
    ds_write_b128 v91, v[184:187] offset:2048
    v_add_f32 v7, v7, v94
    v_mfma_f32_16x16x32_bf16 v[124:127], a[180:183], v[28:31], v[124:127]
    buffer_load_dwordx4 v85, s[20:23], s30 offen offset:3072 lds
    v_mfma_f32_16x16x32_bf16 v[196:199], a[0:3], v[96:99], 0
    ds_write_b128 v90, v[140:143] offset:6144
    v_add_f32 v58, v58, v7
    v_mfma_f32_16x16x32_bf16 v[144:147], a[152:155], v[24:27], v[144:147]
    v_exp_f32 v53, v9
    v_mfma_f32_16x16x32_bf16 v[164:167], a[156:159], v[24:27], v[164:167]
    ds_write_b32 v91, v58 offset:10248
    ds_read_b64_tr_b16 v[122:123], v63 offset:18432
    v_mfma_f32_16x16x32_bf16 v[12:15], a[104:107], a[56:59], v[12:15]
    ds_read_b64_tr_b16 v[162:163], v95 offset:18432
    buffer_load_dwordx4 v82, s[20:23], s30 offen offset:0 lds
    ds_read_b64_tr_b16 v[222:223], v62 offset:18432
    v_mfma_f32_16x16x32_bf16 v[12:15], a[108:111], a[60:63], v[12:15]
    ds_read_b64_tr_b16 v[182:183], v61 offset:18432
    v_max_u32 v4, v4, v58
    v_mfma_f32_16x16x32_bf16 v[104:107], a[144:147], v[24:27], v[104:107]
    s_xor_b32 s30, s37, 786432
    ds_read_b64_tr_b16 v[120:121], v63 offset:16384
    v_lshlrev_b32 v76, 4, v76
    v_xor_b32 v77, s2, v77
    v_mfma_f32_16x16x32_bf16 v[144:147], a[184:187], v[28:31], v[144:147]
    ds_read_b64_tr_b16 a[48:49], v86 offset:32768
    v_cvt_pk_bf16_f32 v25, v54, v55
    v_mfma_f32_16x16x32_bf16 v[104:107], a[176:179], v[28:31], v[104:107]
    ds_read_b64_tr_b16 a[54:55], v87 offset:34816
    v_exp_f32 v52, v8
    v_mfma_f32_16x16x32_bf16 v[16:19], a[124:127], a[60:63], v[16:19]
    s_add_u32 m0, s27, 81920
    v_cvt_pk_bf16_f32 v24, v52, v53
    v_exp_f32 v55, v15
    v_exp_f32 v52, v12
    v_exp_f32 v53, v13
    v_exp_f32 v54, v14
    v_cvt_pk_bf16_f32 v26, v52, v53
    v_mfma_f32_16x16x32_bf16 v[8:11], a[80:83], a[64:67], v[48:51]
    s_waitcnt lgkmcnt(7)
    ds_read_b64_tr_b16 a[50:51], v86 offset:34816
    v_lshl_add_u32 v76, v77, 7, v76
    v_mfma_f32_16x16x32_bf16 v[12:15], a[96:99], a[64:67], v[48:51]
    s_barrier
    ds_read_b128 v[36:39], v90 offset:7168
    v_mfma_f32_16x16x32_bf16 v[8:11], a[84:87], a[68:71], v[8:11]
    v_add_u32 v67, s60, v76
    v_cvt_pk_bf16_f32 v27, v54, v55
    v_mfma_f32_16x16x32_bf16 v[20:23], a[140:143], a[60:63], v[20:23]
    v_exp_f32 v53, v17
    v_mfma_f32_16x16x32_bf16 v[108:111], a[144:147], v[24:27], v[108:111]
    s_waitcnt vmcnt(20) lgkmcnt(3)
    ds_read_b128 v[32:35], v90 offset:2048
    buffer_load_dwordx4 v85, s[20:23], s30 offen offset:3072 lds
    ds_read_b64_tr_b16 a[86:87], v62 offset:34816
    v_mfma_f32_16x16x32_bf16 v[228:231], a[168:171], v[24:27], v[228:231]
    s_waitcnt vmcnt(13)
    ds_read_b32 v5, v90 offset:10248
    v_exp_f32 v55, v19
    v_mfma_f32_16x16x32_bf16 v[208:211], a[164:167], v[24:27], v[208:211]
    s_cmp_eq_u64 vcc, 0
    s_cselect_b64 s[46:47], s[44:45], s[54:55]
    ds_read_b64_tr_b16 a[56:57], v88 offset:32768
    v_exp_f32 v52, v16
    v_mfma_f32_16x16x32_bf16 v[164:167], a[188:191], v[28:31], v[164:167]
    s_add_u32 s99, s99, s60
    ds_read_b64_tr_b16 a[58:59], v88 offset:34816
    buffer_load_dwordx4 v82, s[20:23], s30 offen offset:0 lds
    ds_read_b64_tr_b16 a[96:97], v86 offset:49152
    v_mfma_f32_16x16x32_bf16 v[188:191], a[160:163], v[24:27], v[188:191]
    ds_read_b64_tr_b16 a[62:63], v89 offset:34816
    v_exp_f32 v54, v18
    v_cvt_pk_bf16_f32 v28, v52, v53
    v_mfma_f32_16x16x32_bf16 v[128:131], a[148:151], v[24:27], v[128:131]
    s_waitcnt lgkmcnt(7)
    ds_read_b128 v[40:43], v92 offset:0
    v_exp_f32 v52, v20
    v_mfma_f32_16x16x32_bf16 v[144:147], a[234:237], v[36:39], v[144:147]
    buffer_load_dwordx4 v83, s[20:23], s30 offen offset:1024 lds
    ds_read_b64_tr_b16 a[60:61], v89 offset:32768
    v_cvt_pk_bf16_f32 v29, v54, v55
    v_exp_f32 v55, v23
    v_mfma_f32_16x16x32_bf16 v[164:167], a[232:235], v[36:39], v[164:167]
    s_waitcnt lgkmcnt(6)
    v_add_f32 v58, v58, v5
    v_mov_b32 v70, 0
    v_cmp_nge_f32 vcc, s38, v58
    v_mfma_f32_16x16x32_bf16 v[12:15], a[100:103], a[68:71], v[12:15]
    v_rcp_f32 v58, v58
    v_mfma_f32_16x16x32_bf16 v[104:107], a[234:237], v[32:35], v[104:107]
    buffer_load_dwordx4 v84, s[20:23], s30 offen offset:2048 lds
    ds_read_b64_tr_b16 a[80:81], v61 offset:32768
    v_mfma_f32_16x16x32_bf16 v[124:127], a[232:235], v[32:35], v[124:127]
    s_mov_b32 s7, 0x20000
    v_exp_f32 v53, v21
    v_exp_f32 v54, v22
    v_mfma_f32_16x16x32_bf16 v[248:251], a[172:175], v[24:27], v[248:251]
    s_add_u32 m0, s27, 32768
    ds_read_b64_tr_b16 a[98:99], v86 offset:51200
    v_mul_f32 v107, v58, v107
    v_mfma_f32_16x16x32_bf16 v[12:15], a[104:107], a[72:75], v[12:15]
    s_xor_b32 s30, s37, 851968
    v_mov_b32 v69, s99
    v_mul_f32 v145, v58, v145
    v_cvt_pk_bf16_f32 v30, v52, v53
    v_mfma_f32_16x16x32_bf16 v[20:23], a[128:131], a[64:67], v[48:51]
    v_mul_f32 v164, v58, v164
    v_cvt_pk_bf16_f32 v31, v54, v55
    v_mul_f32 v105, v58, v105
    v_mul_f32 v125, v58, v125
    v_mul_f32 v104, v58, v104
    v_mfma_f32_16x16x32_bf16 v[12:15], a[108:111], a[76:79], v[12:15]
    s_waitcnt vmcnt(12) lgkmcnt(2)
    ds_read_b64_tr_b16 a[82:83], v61 offset:34816
    buffer_load_dwordx4 v85, s[20:23], s30 offen offset:3072 lds
    v_mul_f32 v166, v58, v166
    v_mul_f32 v147, v58, v147
    v_mul_f32 v106, v58, v106
    v_mul_f32 v127, v58, v127
    v_mul_f32 v146, v58, v146
    v_mul_f32 v165, v58, v165
    v_mov_b32 v70, 1
    v_mul_f32 v144, v58, v144
    v_mul_f32 v126, v58, v126
    v_cvt_pk_bf16_f32 v104, v104, v105
    v_mov_b32 v74, 0
    v_cvt_pk_bf16_f32 v105, v106, v107
    v_mfma_f32_16x16x32_bf16 v[20:23], a[132:135], a[68:71], v[20:23]
    s_mov_b64 exec, s[44:45]
    global_atomic_umax v67, v70, s[24:25] sc1
    s_mov_b64 exec, -1
    v_mul_f32 v124, v58, v124
    v_mfma_f32_16x16x32_bf16 v[8:11], a[88:91], a[72:75], v[8:11]
    ds_read_b64_tr_b16 a[84:85], v62 offset:32768
    buffer_load_dwordx4 v84, s[20:23], s30 offen offset:2048 lds
    ds_read_b64_tr_b16 a[106:107], v88 offset:51200
    v_mfma_f32_16x16x32_bf16 v[188:191], a[192:195], v[28:31], v[188:191]
    ds_read_b64_tr_b16 a[90:91], v63 offset:34816
    v_cvt_pk_bf16_f32 v106, v124, v125
    v_cvt_pk_bf16_f32 v107, v126, v127
    v_mul_f32 v167, v58, v167
    v_cvt_pk_bf16_f32 v144, v144, v145
    v_mfma_f32_16x16x32_bf16 v[8:11], a[92:95], a[76:79], v[8:11]
    s_lshl2_add_u32 s99, s2, s26
    ds_read_b128 a[220:223], v92 offset:5120
    v_accvgpr_mov_b32 a217, a225
    v_mfma_f32_16x16x32_bf16 v[228:231], a[200:203], v[28:31], v[228:231]
    ds_read_b64_tr_b16 a[110:111], v89 offset:51200
    buffer_load_dwordx4 v83, s[20:23], s30 offen offset:1024 lds
    ds_read_b64_tr_b16 a[92:93], v95 offset:32768
    v_mfma_f32_16x16x32_bf16 v[16:19], a[112:115], a[64:67], v[48:51]
    ds_read_b64_tr_b16 a[94:95], v95 offset:34816
    buffer_store_dwordx4 v[104:107], v64, s[16:19], s36 offen offset:0 sc0 sc1
    v_mov_b32 v70, 2
    v_cvt_pk_bf16_f32 v145, v146, v147
    v_cvt_pk_bf16_f32 v188, v188, v189
    v_exp_f32 v52, v8
    v_smfmac_f32_16x16x64_bf16 a[216:219], a[228:231], v[24:31], v60
    buffer_load_dwordx4 v82, s[20:23], s30 offen offset:0 lds
    ds_read_b64_tr_b16 a[88:89], v63 offset:32768
    v_cvt_pk_bf16_f32 v146, v164, v165
    v_mfma_f32_16x16x32_bf16 v[16:19], a[116:119], a[68:71], v[16:19]
    s_lshl2_add_u32 s98, s98, s26
    v_exp_f32 v54, v10
    v_mfma_f32_16x16x32_bf16 v[208:211], a[196:199], v[28:31], v[208:211]
    ds_read_b64_tr_b16 a[108:109], v89 offset:49152
    v_accvgpr_read_b32 v3, a217
    v_cvt_pk_bf16_f32 v189, v190, v191
    v_cvt_pk_bf16_f32 v147, v166, v167
    v_mfma_f32_16x16x32_bf16 v[16:19], a[120:123], a[72:75], v[16:19]
    ds_read_b64_tr_b16 a[104:105], v88 offset:49152
    v_accvgpr_read_b32 v59, a216
    v_lshlrev_b32 v68, 2, v0
    v_mfma_f32_16x16x32_bf16 v[248:251], a[204:207], v[28:31], v[248:251]
    ds_read_b64_tr_b16 v[184:185], v86 offset:0
    buffer_store_dwordx4 v[144:147], v64, s[16:19], s36 offen offset:1024 sc0 sc1
    ds_read_b64_tr_b16 a[102:103], v87 offset:51200
    v_accvgpr_read_b32 v94, a219
    v_mfma_f32_16x16x32_bf16 v[168:171], a[156:159], v[24:27], v[168:171]
    s_xor_b32 s30, s37, 917504
    ds_read_b64_tr_b16 a[100:101], v87 offset:49152
    v_cvt_pk_bf16_f32 v191, v210, v211
    v_mfma_f32_16x16x32_bf16 v[16:19], a[124:127], a[76:79], v[16:19]
    s_add_u32 m0, s27, 98304
    ds_read_b128 a[224:227], v91 offset:0
    v_accvgpr_read_b32 v7, a218
    v_cvt_pk_bf16_f32 v228, v228, v229
    v_exp_f32 v55, v11
    v_mfma_f32_16x16x32_bf16 v[196:199], a[8:11], v[136:139], v[196:199]
    s_waitcnt vmcnt(13) lgkmcnt(6)
    v_add_f32 v59, v59, v3
    v_add_f32 v7, v7, v94
    v_mfma_f32_16x16x32_bf16 v[148:151], a[152:155], v[24:27], v[148:151]
    s_mov_b64 exec, s[46:47]
    global_atomic_umax v67, v70, s[24:25] sc1
    s_mov_b64 exec, -1
    ds_write_b128 v90, v[144:147] offset:7168
    buffer_load_dwordx4 v84, s[20:23], s30 offen offset:2048 lds
    v_cvt_pk_bf16_f32 v190, v208, v209
    v_cvt_pk_bf16_f32 v229, v230, v231
    v_cvt_pk_bf16_f32 v230, v248, v249
    v_add_f32 v59, v59, v7
    v_cvt_pk_bf16_f32 v25, v54, v55
    v_cvt_pk_bf16_f32 v231, v250, v251
    v_mfma_f32_16x16x32_bf16 v[20:23], a[136:139], a[72:75], v[20:23]
    ds_write_b128 v90, v[104:107] offset:2048
    buffer_atomic_umax v74, v68, s[4:7], 0 offen sc0 sc1
    buffer_load_dwordx4 v82, s[20:23], s30 offen offset:0 lds
    v_exp_f32 v54, v14
    v_mfma_f32_16x16x32_bf16 v[20:23], a[140:143], a[76:79], v[20:23]
    ds_write_b128 v91, v[228:231] offset:8192
    v_exp_f32 v55, v15
    v_exp_f32 v53, v9
    v_mfma_f32_16x16x32_bf16 v[128:131], a[180:183], v[28:31], v[128:131]
    buffer_load_dwordx4 v85, s[20:23], s30 offen offset:3072 lds
    ds_write_b32 v91, v59 offset:10252
    ds_write_b128 v91, v[188:191] offset:3072
    v_mfma_f32_16x16x32_bf16 v[108:111], a[176:179], v[28:31], v[108:111]
    v_mov_b32 v75, 0
    v_cvt_pk_bf16_f32 v24, v52, v53
    v_cvt_pk_bf16_f32 v27, v54, v55
    v_exp_f32 v52, v12
    v_exp_f32 v55, v19
    v_exp_f32 v53, v13
    v_mfma_f32_16x16x32_bf16 v[148:151], a[184:187], v[28:31], v[148:151]
    ds_read_b128 a[208:211], v91 offset:5120
    v_exp_f32 v54, v18
    v_mfma_f32_16x16x32_bf16 v[168:171], a[188:191], v[28:31], v[168:171]
    v_cvt_pk_bf16_f32 v29, v54, v55
    v_cvt_pk_bf16_f32 v26, v52, v53
    v_exp_f32 v52, v16
    v_exp_f32 v53, v17
    v_exp_f32 v55, v23
    v_exp_f32 v54, v22
    v_cvt_pk_bf16_f32 v28, v52, v53
    v_exp_f32 v53, v21
    v_cvt_pk_bf16_f32 v31, v54, v55
    v_mfma_f32_16x16x32_bf16 v[192:195], a[160:163], v[24:27], v[192:195]
    s_waitcnt lgkmcnt(1)
    v_exp_f32 v52, v20
    v_mfma_f32_16x16x32_bf16 v[232:235], a[168:171], v[24:27], v[232:235]
    s_barrier
    v_cvt_pk_bf16_f32 v30, v52, v53
    v_max_u32 v4, v4, v59
    v_mfma_f32_16x16x32_bf16 v[212:215], a[164:167], v[24:27], v[212:215]
    s_add_u32 s10, s56, 8192
    ds_read_b128 v[32:35], v90 offset:3072
    buffer_load_dwordx4 v83, s[20:23], s30 offen offset:1024 lds
    ds_read_b128 v[36:39], v90 offset:8192
    v_smfmac_f32_16x16x64_bf16 a[212:215], a[228:231], v[24:31], v60
    ds_read_b64_tr_b16 v[164:165], v89 offset:0
    v_mfma_f32_16x16x32_bf16 v[232:235], a[200:203], v[28:31], v[232:235]
    s_cmp_eq_u64 vcc, 0
    s_cselect_b64 s[48:49], s[46:47], s[54:55]
    ds_read_b32 v6, v90 offset:10252
    v_mfma_f32_16x16x32_bf16 v[192:195], a[192:195], v[28:31], v[192:195]
    s_xor_b32 s30, s37, 983040
    ds_read_b64_tr_b16 v[224:225], v87 offset:0
    v_accvgpr_read_b32 v3, a213
    v_mfma_f32_16x16x32_bf16 v[252:255], a[172:175], v[24:27], v[252:255]
    s_add_u32 m0, s27, 49152
    ds_read_b64_tr_b16 v[166:167], v89 offset:2048
    buffer_load_dwordx4 v82, s[20:23], s30 offen offset:0 lds
    ds_read_b64_tr_b16 v[226:227], v87 offset:2048
    v_mfma_f32_16x16x32_bf16 v[212:215], a[196:199], v[28:31], v[212:215]
    s_mul_i32 s99, s99, 5120
    ds_read_b64_tr_b16 v[126:127], v88 offset:2048
    v_accvgpr_read_b32 v94, a215
    v_mfma_f32_16x16x32_bf16 v[196:199], a[16:19], a[224:227], v[196:199]
    s_add_u32 s31, s96, 0
    ds_read_b64_tr_b16 a[72:73], v63 offset:0
    v_cvt_pk_bf16_f32 v192, v192, v193
    v_accvgpr_read_b32 v60, a212
    v_cvt_pk_bf16_f32 v193, v194, v195
    v_mfma_f32_16x16x32_bf16 v[252:255], a[204:207], v[28:31], v[252:255]
    ds_read_b64_tr_b16 a[64:65], v61 offset:0
    buffer_load_dwordx4 v84, s[20:23], s30 offen offset:2048 lds
    v_mfma_f32_16x16x32_bf16 v[236:239], a[12:15], v[136:139], v[236:239]
    s_waitcnt lgkmcnt(9)
    v_accvgpr_read_b32 v7, a214
    v_cvt_pk_bf16_f32 v195, v214, v215
    v_mfma_f32_16x16x32_bf16 v[108:111], a[234:237], v[32:35], v[108:111]
    s_waitcnt lgkmcnt(8)
    v_cvt_pk_bf16_f32 v194, v212, v213
    v_add_f32 v7, v7, v94
    v_mfma_f32_16x16x32_bf16 v[168:171], a[232:235], v[36:39], v[168:171]
    v_add_f32 v60, v60, v3
    v_cvt_pk_bf16_f32 v232, v232, v233
    v_cvt_pk_bf16_f32 v233, v234, v235
    v_mfma_f32_16x16x32_bf16 v[148:151], a[234:237], v[36:39], v[148:151]
    s_waitcnt lgkmcnt(6)
    v_add_f32 v59, v59, v6
    v_cmp_nge_f32 vcc, s38, v59
    v_mfma_f32_16x16x32_bf16 v[128:131], a[232:235], v[32:35], v[128:131]
    ds_write_b128 v91, v[192:195] offset:4096
    buffer_load_dwordx4 v83, s[20:23], s30 offen offset:1024 lds
    v_cvt_pk_bf16_f32 v234, v252, v253
    v_rcp_f32 v59, v59
    v_add_f32 v60, v60, v7
    v_cvt_pk_bf16_f32 v235, v254, v255
    v_mfma_f32_16x16x32_bf16 v[240:243], a[4:7], v[100:103], 0
    ds_write_b32 v91, v60 offset:11264
    v_mul_f32 v108, v59, v108
    v_mul_f32 v110, v59, v110
    v_mul_f32 v150, v59, v150
    v_mfma_f32_16x16x32_bf16 v[236:239], a[20:23], a[224:227], v[236:239]
    v_mul_f32 v130, v59, v130
    v_mul_f32 v109, v59, v109
    v_mul_f32 v170, v59, v170
    v_max_u32 v4, v4, v60
    v_mul_f32 v151, v59, v151
    v_mfma_f32_16x16x32_bf16 v[244:247], a[4:7], v[104:107], 0
    ds_write_b32 v90, v4 offset:11268
    ds_write_b128 v91, v[232:235] offset:9216
    v_cvt_pk_bf16_f32 v108, v108, v109
    v_mfma_f32_16x16x32_bf16 v[196:199], a[24:27], a[208:211], v[196:199]
    v_mul_f32 v131, v59, v131
    v_mul_f32 v128, v59, v128
    v_mul_f32 v111, v59, v111
    v_mul_f32 v169, v59, v169
    v_cvt_pk_bf16_f32 v109, v110, v111
    v_mul_f32 v149, v59, v149
    v_mul_f32 v129, v59, v129
    v_cvt_pk_bf16_f32 v111, v130, v131
    v_mul_f32 v171, v59, v171
    v_mul_f32 v168, v59, v168
    v_mul_f32 v148, v59, v148
    v_mfma_f32_16x16x32_bf16 v[236:239], a[28:31], a[208:211], v[236:239]
    v_cvt_pk_bf16_f32 v110, v128, v129
    v_cvt_pk_bf16_f32 v148, v148, v149
    v_mfma_f32_16x16x32_bf16 v[112:115], a[144:147], v[24:27], v[112:115]
    ds_write_b128 v90, v[108:111] offset:3072
    v_mfma_f32_16x16x32_bf16 v[236:239], a[244:247], v[40:43], v[236:239]
    v_cvt_pk_bf16_f32 v149, v150, v151
    v_cvt_pk_bf16_f32 v150, v168, v169
    v_mov_b32 v70, 3
    v_cvt_pk_bf16_f32 v151, v170, v171
    v_mfma_f32_16x16x32_bf16 v[132:135], a[148:151], v[24:27], v[132:135]
    ds_write_b128 v90, v[148:151] offset:8192
    v_mfma_f32_16x16x32_bf16 v[204:207], a[0:3], v[104:107], 0
    buffer_atomic_umax v75, v68, s[4:7], 0 offen sc0 sc1
    v_mfma_f32_16x16x32_bf16 v[236:239], a[252:255], a[220:223], v[236:239]
    buffer_load_dwordx4 v85, s[20:23], s30 offen offset:3072 lds
    ds_read_b64_tr_b16 v[186:187], v86 offset:2048
    v_mfma_f32_16x16x32_bf16 v[172:175], a[156:159], v[24:27], v[172:175]
    buffer_store_dwordx4 v[108:111], v64, s[16:19], s36 offen offset:2048 sc0 sc1
    ds_read_b64_tr_b16 v[124:125], v88 offset:0
    v_mfma_f32_16x16x32_bf16 v[112:115], a[176:179], v[28:31], v[112:115]
    s_waitcnt lgkmcnt(2)
    s_barrier
    ds_read_b128 v[36:39], v90 offset:9216
    v_mfma_f32_16x16x32_bf16 v[172:175], a[188:191], v[28:31], v[172:175]
    ds_read_b32 v53, v91 offset:11268
    ds_read_b32 v5, v90 offset:11264
    v_mfma_f32_16x16x32_bf16 v[132:135], a[180:183], v[28:31], v[132:135]
    s_waitcnt vmcnt(12)
    ds_read_b128 v[32:35], v90 offset:4096
    ds_read_b32 v55, v93 offset:11268
    v_mfma_f32_16x16x32_bf16 v[152:155], a[152:155], v[24:27], v[152:155]
    s_add_u32 m0, s27, 0
    ds_read_b32 v54, v92 offset:11268
    buffer_store_dwordx4 v[148:151], v64, s[16:19], s36 offen offset:3072 sc0 sc1
    ds_read_b64_tr_b16 a[66:67], v61 offset:2048
    v_mfma_f32_16x16x32_bf16 v[204:207], a[8:11], v[144:147], v[204:207]
    s_cmp_eq_u64 vcc, 0
    s_cselect_b64 s[50:51], s[48:49], s[54:55]
    ds_read_b128 a[208:211], v91 offset:1024
    v_mfma_f32_16x16x32_bf16 v[196:199], a[240:243], v[40:43], v[196:199]
    s_mov_b64 exec, s[48:49]
    global_atomic_umax v67, v70, s[24:25] sc1
    s_mov_b64 exec, -1
    v_mfma_f32_16x16x32_bf16 v[200:203], a[0:3], v[100:103], 0
    s_waitcnt vmcnt(11)
    ds_read_b64_tr_b16 a[122:123], v88 offset:18432
    v_cmp_lt_u32 s[12:13], 0, v74
    v_mfma_f32_16x16x32_bf16 v[200:203], a[8:11], v[140:143], v[200:203]
    ds_read_b128 v[44:47], v93 offset:0
    ds_read_b128 a[224:227], v93 offset:5120
    v_mfma_f32_16x16x32_bf16 v[196:199], a[248:251], a[220:223], v[196:199]
    s_waitcnt lgkmcnt(8)
    v_add_f32 v60, v60, v5
    v_max_u32 v4, v4, v53
    v_mfma_f32_16x16x32_bf16 v[152:155], a[184:187], v[28:31], v[152:155]
    v_rcp_f32 v60, v60
    v_mfma_f32_16x16x32_bf16 v[152:155], a[234:237], v[36:39], v[152:155]
    s_waitcnt lgkmcnt(5)
    v_max3_u32 v4, v4, v54, v55
    v_add_f32 v4, v4, v4
    v_cmp_nge_f32 vcc, s38, v4
    v_mfma_f32_16x16x32_bf16 v[112:115], a[234:237], v[32:35], v[112:115]
    s_cmp_lg_u64 vcc, 0
    s_cselect_b32 s3, 1, 0
    s_cmp_gt_u32 s3, s34
    s_cbranch_scc1 L_fallback
    v_mfma_f32_16x16x32_bf16 v[132:135], a[232:235], v[32:35], v[132:135]
    s_andn2_b32 s14, s29, s12
    s_cbranch_scc1 L_sp0
L_rt0:
    ds_read_b64_tr_b16 a[78:79], v95 offset:2048
    buffer_load_dwordx4 v64, s[16:19], s31 offen offset:0 sc0 sc1 lds
    v_mul_f32 v152, v60, v152
    v_mul_f32 v113, v60, v113
    v_mfma_f32_16x16x32_bf16 v[240:243], a[12:15], v[140:143], v[240:243]
    v_mul_f32 v155, v60, v155
    v_mul_f32 v115, v60, v115
    v_mul_f32 v133, v60, v133
    v_mul_f32 v112, v60, v112
    v_mul_f32 v132, v60, v132
    v_mul_f32 v114, v60, v114
    v_cvt_pk_bf16_f32 v112, v112, v113
    v_mfma_f32_16x16x32_bf16 v[172:175], a[232:235], v[36:39], v[172:175]
    s_waitcnt lgkmcnt(2)
    ds_read_b128 a[220:223], v92 offset:1024
    buffer_load_dwordx4 v64, s[16:19], s31 offen offset:1024 sc0 sc1 lds
    v_mul_f32 v134, v60, v134
    v_cvt_pk_bf16_f32 v113, v114, v115
    v_mul_f32 v135, v60, v135
    v_cvt_pk_bf16_f32 v115, v134, v135
    v_cvt_pk_bf16_f32 v114, v132, v133
    v_mfma_f32_16x16x32_bf16 v[196:199], a[32:35], v[44:47], v[196:199]
    ds_read_b128 v[40:43], v91 offset:6144
    buffer_store_dwordx4 v[112:115], v64, s[16:19], s10 offen offset:0 sc0 sc1
    ds_read_b128 v[136:139], v93 offset:6144
    v_mfma_f32_16x16x32_bf16 v[236:239], a[36:39], v[44:47], v[236:239]
    ds_read_b64_tr_b16 a[76:77], v95 offset:0
    v_mul_f32 v154, v60, v154
    v_mul_f32 v172, v60, v172
    v_mul_f32 v174, v60, v174
    v_mul_f32 v153, v60, v153
    v_cvt_pk_bf16_f32 v152, v152, v153
    v_mul_f32 v173, v60, v173
    v_mfma_f32_16x16x32_bf16 v[208:211], a[0:3], v[108:111], 0
    s_waitcnt lgkmcnt(4)
    v_cvt_pk_bf16_f32 v153, v154, v155
    v_mul_f32 v175, v60, v175
    v_cvt_pk_bf16_f32 v154, v172, v173
    v_cvt_pk_bf16_f32 v155, v174, v175
    v_mfma_f32_16x16x32_bf16 v[196:199], a[40:43], a[224:227], v[196:199]
    buffer_store_dwordx4 v[152:155], v64, s[16:19], s10 offen offset:1024 sc0 sc1
    ds_read_b64_tr_b16 a[74:75], v63 offset:2048
    v_mfma_f32_16x16x32_bf16 v[240:243], a[20:23], a[208:211], v[240:243]
    s_mul_i32 s98, s98, 10240
    ds_read_b128 v[44:47], v92 offset:6144
    v_add_u32 v65, 65536, v64
    v_mfma_f32_16x16x32_bf16 v[236:239], a[44:47], a[224:227], v[236:239]
    s_add_u32 m0, s27, 2048
    ds_read_b64_tr_b16 a[70:71], v62 offset:2048
    s_add_u32 s31, s97, 0
    ds_read_b64_tr_b16 a[68:69], v62 offset:0
    v_mfma_f32_16x16x32_bf16 v[200:203], a[16:19], a[208:211], v[200:203]
    s_waitcnt lgkmcnt(6)
    ds_read_b128 a[224:227], v91 offset:2048
    v_mfma_f32_16x16x32_bf16 v[200:203], a[24:27], v[40:43], v[200:203]
    ds_read_b128 v[140:143], v93 offset:7168
    buffer_load_dwordx4 v64, s[16:19], s31 offen offset:1024 sc0 sc1 lds
    ds_read_b128 v[96:99], v93 offset:1024
    v_mfma_f32_16x16x32_bf16 v[244:247], a[12:15], v[144:147], v[244:247]
    ds_read_b64_tr_b16 a[134:135], v62 offset:18432
    v_mfma_f32_16x16x32_bf16 v[208:211], a[8:11], v[148:151], v[208:211]
    ds_write_b128 v90, v[152:155] offset:9216
    v_mfma_f32_16x16x32_bf16 v[200:203], a[240:243], a[220:223], v[200:203]
    buffer_load_dwordx4 v64, s[16:19], s31 offen offset:0 sc0 sc1 lds
    v_mfma_f32_16x16x32_bf16 v[240:243], a[28:31], v[40:43], v[240:243]
    s_add_u32 s31, s98, 0
    s_add_u32 m0, s27, 65536
    ds_read_b64_tr_b16 a[114:115], v86 offset:18432
    s_waitcnt lgkmcnt(8)
    v_mfma_f32_16x16x32_bf16 v[200:203], a[248:251], v[44:47], v[200:203]
    ds_read_b128 v[40:43], v92 offset:2048
    v_mfma_f32_16x16x32_bf16 v[248:251], a[4:7], v[108:111], 0
    ds_read_b64_tr_b16 a[118:119], v87 offset:18432
    ds_read_b64_tr_b16 a[112:113], v86 offset:16384
    s_add_u32 s99, s99, 12582912
    ds_read_b128 a[208:211], v91 offset:7168
    v_mfma_f32_16x16x32_bf16 v[240:243], a[244:247], a[220:223], v[240:243]
    s_waitcnt lgkmcnt(9)
    ds_read_b64_tr_b16 a[126:127], v89 offset:18432
    buffer_load_dwordx4 v64, s[16:19], s31 offen offset:1024 sc0 sc1 lds
    ds_read_b128 a[220:223], v92 offset:7168
    v_mfma_f32_16x16x32_bf16 v[252:255], a[4:7], v[112:115], 0
    ds_read_b128 v[100:103], v93 offset:2048
    v_mov_b32 v70, 4
    v_mfma_f32_16x16x32_bf16 v[240:243], a[252:255], v[44:47], v[240:243]
    s_waitcnt lgkmcnt(9)
    ds_write_b128 v90, v[112:115] offset:4096
    v_mfma_f32_16x16x32_bf16 v[200:203], a[32:35], v[96:99], v[200:203]
    buffer_load_dwordx4 v64, s[16:19], s31 offen offset:0 sc0 sc1 lds
    v_mfma_f32_16x16x32_bf16 v[240:243], a[36:39], v[96:99], v[240:243]
    s_add_u32 s31, s96, 2048
    ds_read_b64_tr_b16 a[138:139], v63 offset:18432
    v_mfma_f32_16x16x32_bf16 v[240:243], a[44:47], v[136:139], v[240:243]
    ds_read_b64_tr_b16 a[120:121], v88 offset:16384
    s_waitcnt vmcnt(12)
    v_cmp_lt_u32 s[12:13], 1, v75
    v_mfma_f32_16x16x32_bf16 v[212:215], a[0:3], v[112:115], 0
    ds_read_b64_tr_b16 a[140:141], v95 offset:16384
    ds_read_b64_tr_b16 a[156:157], v89 offset:32768
    v_mfma_f32_16x16x32_bf16 v[252:255], a[12:15], v[152:155], v[252:255]
    ds_read_b128 v[44:47], v91 offset:3072
    ds_read_b64_tr_b16 a[166:167], v62 offset:34816
    v_mfma_f32_16x16x32_bf16 v[248:251], a[12:15], v[148:151], v[248:251]
    ds_read_b64_tr_b16 a[124:125], v89 offset:16384
    s_add_u32 m0, s27, 67584
    v_mfma_f32_16x16x32_bf16 v[244:247], a[20:23], a[224:227], v[244:247]
    s_waitcnt lgkmcnt(10)
    ds_read_b64_tr_b16 a[116:117], v87 offset:16384
    v_mov_b32 v59, -1
    v_mfma_f32_16x16x32_bf16 v[244:247], a[28:31], a[208:211], v[244:247]
    ds_read_b128 v[96:99], v91 offset:8192
    v_mov_b32 v57, -1
    v_mfma_f32_16x16x32_bf16 v[204:207], a[16:19], a[224:227], v[204:207]
    s_andn2_b32 s14, s29, s12
    s_cbranch_scc1 L_sp1
L_rt1:
    ds_read_b64_tr_b16 a[144:145], v86 offset:32768
    buffer_atomic_umax v74, v68, s[4:7], 0 offen sc0 sc1
    ds_read_b64_tr_b16 a[172:173], v95 offset:32768
    v_mfma_f32_16x16x32_bf16 v[200:203], a[40:43], v[136:139], v[200:203]
    ds_read_b64_tr_b16 a[170:171], v63 offset:34816
    buffer_load_dwordx4 v64, s[16:19], s31 offen offset:1024 sc0 sc1 lds
    v_mfma_f32_16x16x32_bf16 v[204:207], a[24:27], a[208:211], v[204:207]
    s_waitcnt lgkmcnt(11)
    ds_read_b64_tr_b16 a[160:161], v61 offset:32768
    ds_read_b128 v[136:139], v92 offset:3072
    v_mfma_f32_16x16x32_bf16 v[212:215], a[8:11], v[152:155], v[212:215]
    s_barrier
    ds_read_b64_tr_b16 a[154:155], v88 offset:34816
    v_mfma_f32_16x16x32_bf16 v[244:247], a[244:247], v[40:43], v[244:247]
    s_waitcnt lgkmcnt(10)
    ds_read_b128 a[208:211], v91 offset:9216
    buffer_load_dwordx4 v64, s[16:19], s31 offen offset:0 sc0 sc1 lds
    v_mfma_f32_16x16x32_bf16 v[248:251], a[20:23], v[44:47], v[248:251]
    ds_read_b128 a[224:227], v91 offset:4096
    s_add_u32 s31, s97, 2048
    v_mfma_f32_16x16x32_bf16 v[204:207], a[240:243], v[40:43], v[204:207]
    s_waitcnt vmcnt(14)
    ds_read_b64_tr_b16 a[152:153], v88 offset:32768
    s_add_u32 m0, s27, 16384
    ds_read_b64_tr_b16 a[168:169], v63 offset:32768
    s_add_u32 s28, s99, 4096
    ds_read_b64_tr_b16 a[184:185], v88 offset:49152
    v_mfma_f32_16x16x32_bf16 v[204:207], a[248:251], a[220:223], v[204:207]
    ds_read_b64_tr_b16 a[164:165], v62 offset:32768
    ds_read_b128 v[40:43], v92 offset:4096
    ds_read_b64_tr_b16 a[186:187], v88 offset:51200
    v_mfma_f32_16x16x32_bf16 v[244:247], a[252:255], a[220:223], v[244:247]
    s_waitcnt lgkmcnt(11)
    ds_read_b64_tr_b16 a[148:149], v87 offset:32768
    buffer_load_dwordx4 v64, s[16:19], s31 offen offset:0 sc0 sc1 lds
    v_mfma_f32_16x16x32_bf16 v[204:207], a[32:35], v[100:103], v[204:207]
    s_waitcnt vmcnt(13)
    s_mov_b64 exec, s[50:51]
    global_atomic_umax v67, v70, s[24:25] sc1
    s_mov_b64 exec, -1
    v_mfma_f32_16x16x32_bf16 v[244:247], a[36:39], v[100:103], v[244:247]
    ds_read_b128 v[48:51], v93 offset:3072
    v_mov_b32 v58, -1
    v_mfma_f32_16x16x32_bf16 v[244:247], a[44:47], v[140:143], v[244:247]
    ds_read_b128 a[216:219], v92 offset:8192
    v_mfma_f32_16x16x32_bf16 v[248:251], a[28:31], v[96:99], v[248:251]
    s_waitcnt lgkmcnt(9)
    ds_read_b64_tr_b16 a[158:159], v89 offset:34816
    buffer_load_dwordx4 v64, s[16:19], s31 offen offset:1024 sc0 sc1 lds
    v_mfma_f32_16x16x32_bf16 v[252:255], a[20:23], a[224:227], v[252:255]
    ds_read_b64_tr_b16 a[146:147], v86 offset:34816
    s_add_u32 m0, s27, 18432
    v_mfma_f32_16x16x32_bf16 v[212:215], a[16:19], a[224:227], v[212:215]
    ds_read_b64_tr_b16 a[182:183], v87 offset:51200
    s_add_u32 s31, s98, 2048
    v_mfma_f32_16x16x32_bf16 v[208:211], a[16:19], v[44:47], v[208:211]
    ds_read_b128 v[100:103], v93 offset:4096
    v_mfma_f32_16x16x32_bf16 v[208:211], a[24:27], v[96:99], v[208:211]
    ds_read_b64_tr_b16 a[176:177], v86 offset:49152
    v_add_u32 v66, 131072, v64
    v_mfma_f32_16x16x32_bf16 v[212:215], a[24:27], a[208:211], v[212:215]
    buffer_load_dwordx4 v64, s[16:19], s31 offen offset:1024 sc0 sc1 lds
    ds_read_b128 a[220:223], v92 offset:9216
    v_mfma_f32_16x16x32_bf16 v[204:207], a[40:43], v[140:143], v[204:207]
    s_waitcnt lgkmcnt(8)
    ds_read_b128 v[188:191], v93 offset:8192
    v_mfma_f32_16x16x32_bf16 v[212:215], a[240:243], v[40:43], v[212:215]
    ds_read_b64_tr_b16 a[132:133], v62 offset:16384
    v_mfma_f32_16x16x32_bf16 v[208:211], a[240:243], v[136:139], v[208:211]
    ds_read_b64_tr_b16 a[188:189], v89 offset:49152
    v_mfma_f32_16x16x32_bf16 v[248:251], a[244:247], v[136:139], v[248:251]
    s_waitcnt lgkmcnt(9)
    v_mov_b32 v70, 5
    ds_read_b128 v[140:143], v93 offset:9216
    v_mfma_f32_16x16x32_bf16 v[248:251], a[252:255], a[216:219], v[248:251]
    ds_read_b64_tr_b16 a[142:143], v95 offset:18432
    buffer_load_dwordx4 v64, s[16:19], s31 offen offset:0 sc0 sc1 lds
    v_mfma_f32_16x16x32_bf16 v[252:255], a[28:31], a[208:211], v[252:255]
    ds_read_b64_tr_b16 a[178:179], v86 offset:51200
    v_mfma_f32_16x16x32_bf16 v[208:211], a[248:251], a[216:219], v[208:211]
    v_mov_b32 v56, -1
    v_mfma_f32_16x16x32_bf16 v[208:211], a[32:35], v[48:51], v[208:211]
    ds_read_b64_tr_b16 a[136:137], v63 offset:16384
    v_mfma_f32_16x16x32_bf16 v[248:251], a[36:39], v[48:51], v[248:251]
    ds_read_b64_tr_b16 a[130:131], v61 offset:18432
    s_waitcnt lgkmcnt(7)
    v_mfma_f32_16x16x32_bf16 v[248:251], a[44:47], v[188:191], v[248:251]
    ds_read_b64_tr_b16 a[128:129], v61 offset:16384
    s_add_u32 s31, s96, 4096
    v_mfma_f32_16x16x32_bf16 v[212:215], a[248:251], a[220:223], v[212:215]
    v_mfma_f32_16x16x32_bf16 v[208:211], a[40:43], v[188:191], v[208:211]
    ds_read_b64_tr_b16 a[150:151], v87 offset:34816
    ds_read_b64_tr_b16 a[190:191], v89 offset:51200
    v_mfma_f32_16x16x32_bf16 v[252:255], a[244:247], v[40:43], v[252:255]
    s_waitcnt vmcnt(8)
    s_barrier
    ds_read_b128 v[228:231], v64 offset:0
    v_mfma_f32_16x16x32_bf16 v[252:255], a[252:255], a[220:223], v[252:255]
    ds_read_b128 v[8:11], v64 offset:1024
    s_mov_b64 exec, 14
    global_atomic_umax v67, v70, s[24:25] sc1
    s_mov_b64 exec, -1
    s_add_u32 m0, s27, 81920
    ds_read_b128 v[12:15], v64 offset:4096
    v_mfma_f32_16x16x32_bf16 v[252:255], a[36:39], v[100:103], v[252:255]
    ds_read_b128 v[24:27], v64 offset:3072
    buffer_store_dwordx4 v[56:59], v64, s[16:19], s99 offen offset:2048 sc0 sc1
    ds_read_b128 v[168:171], v64 offset:8192
    v_mfma_f32_16x16x32_bf16 v[212:215], a[32:35], v[100:103], v[212:215]
    s_waitcnt lgkmcnt(7)
    ds_read_b128 v[128:131], v64 offset:5120
    v_mfma_f32_16x16x32_bf16 v[252:255], a[44:47], v[140:143], v[252:255]
    ds_read_b128 v[104:107], v64 offset:9216
    buffer_store_dwordx4 v[56:59], v64, s[16:19], s28 offen offset:0 sc0 sc1
    v_mfma_f32_16x16x32_bf16 v[212:215], a[40:43], v[140:143], v[212:215]
    ds_read_b128 v[28:31], v64 offset:10240
    s_waitcnt lgkmcnt(7)
    v_mfma_f32_16x16x32_bf16 v[236:239], v[216:219], v[228:231], v[236:239]
    ds_read_b64_tr_b16 a[180:181], v87 offset:49152
    s_waitcnt lgkmcnt(7)
    v_mfma_f32_16x16x32_bf16 v[236:239], v[156:159], v[8:11], v[236:239]
    ds_read_b128 v[144:147], v64 offset:12288
    v_mfma_f32_16x16x32_bf16 v[196:199], v[176:179], v[228:231], v[196:199]
    ds_read_b128 v[16:19], v64 offset:13312
    v_mfma_f32_16x16x32_bf16 v[196:199], v[116:119], v[8:11], v[196:199]
    s_waitcnt lgkmcnt(8)
    ds_read_b128 v[20:23], v64 offset:2048
    v_mov_b32 v70, 1
    v_mfma_f32_16x16x32_bf16 v[196:199], v[180:183], v[12:15], v[196:199]
    ds_read_b128 a[192:195], v64 offset:11264
    v_mfma_f32_16x16x32_bf16 v[236:239], v[220:223], v[12:15], v[236:239]
    s_waitcnt lgkmcnt(7)
    v_mfma_f32_16x16x32_bf16 v[236:239], v[160:163], v[128:131], v[236:239]
    ds_read_b128 a[196:199], v64 offset:14336
    v_mfma_f32_16x16x32_bf16 v[236:239], a[52:55], v[168:171], v[236:239]
    ds_read_b128 a[212:215], v64 offset:6144
    v_mfma_f32_16x16x32_bf16 v[196:199], v[120:123], v[128:131], v[196:199]
    s_waitcnt vmcnt(10) lgkmcnt(8)
    ds_read_b128 a[228:231], v64 offset:7168
    v_cmp_lt_u32 s[12:13], 2, v74
    v_mfma_f32_16x16x32_bf16 v[196:199], a[48:51], v[168:171], v[196:199]
    s_andn2_b32 s14, s29, s12
    s_cbranch_scc1 L_sp2
L_rt2:
    ds_read_b128 v[128:131], v65 offset:5120
    v_mfma_f32_16x16x32_bf16 v[196:199], a[56:59], v[104:107], v[196:199]
    s_waitcnt lgkmcnt(7)
    v_mfma_f32_16x16x32_bf16 v[196:199], a[80:83], v[144:147], v[196:199]
    buffer_atomic_umax v75, v68, s[4:7], 0 offen sc0 sc1
    v_mfma_f32_16x16x32_bf16 v[236:239], a[60:63], v[104:107], v[236:239]
    buffer_load_dwordx4 v64, s[16:19], s31 offen offset:0 sc0 sc1 lds
    v_mfma_f32_16x16x32_bf16 v[236:239], a[84:87], v[144:147], v[236:239]
    s_waitcnt lgkmcnt(5)
    ds_read_b128 v[12:15], v65 offset:4096
    v_mfma_f32_16x16x32_bf16 v[236:239], a[92:95], v[16:19], v[236:239]
    ds_read_b128 a[200:203], v64 offset:15360
    v_mfma_f32_16x16x32_bf16 v[196:199], a[88:91], v[16:19], v[196:199]
    ds_read_b128 v[228:231], v65 offset:0
    v_mfma_f32_16x16x32_bf16 v[236:239], a[100:103], v[20:23], v[236:239]
    buffer_load_dwordx4 v64, s[16:19], s31 offen offset:1024 sc0 sc1 lds
    v_mfma_f32_16x16x32_bf16 v[236:239], a[108:111], v[24:27], v[236:239]
    s_waitcnt lgkmcnt(5)
    ds_read_b128 v[144:147], v65 offset:12288
    v_mfma_f32_16x16x32_bf16 v[236:239], v[224:227], a[212:215], v[236:239]
    s_waitcnt lgkmcnt(5)
    ds_read_b128 v[168:171], v65 offset:8192
    v_mfma_f32_16x16x32_bf16 v[196:199], a[96:99], v[20:23], v[196:199]
    s_add_u32 m0, s27, 83968
    s_add_u32 s31, s97, 4096
    v_mfma_f32_16x16x32_bf16 v[236:239], v[164:167], a[228:231], v[236:239]
    buffer_load_dwordx4 v64, s[16:19], s31 offen offset:0 sc0 sc1 lds
    v_mfma_f32_16x16x32_bf16 v[236:239], a[68:71], v[28:31], v[236:239]
    ds_read_b64_tr_b16 a[162:163], v61 offset:34816
    s_add_u32 s8, s8, 114688
    v_mfma_f32_16x16x32_bf16 v[196:199], a[104:107], v[24:27], v[196:199]
    ds_read_b128 v[8:11], v65 offset:1024
    v_mfma_f32_16x16x32_bf16 v[196:199], v[184:187], a[212:215], v[196:199]
    v_mfma_f32_16x16x32_bf16 v[196:199], v[124:127], a[228:231], v[196:199]
    buffer_load_dwordx4 v64, s[16:19], s31 offen offset:1024 sc0 sc1 lds
    v_mfma_f32_16x16x32_bf16 v[196:199], a[64:67], v[28:31], v[196:199]
    ds_read_b128 v[16:19], v65 offset:13312
    s_add_u32 m0, s27, 32768
    v_mfma_f32_16x16x32_bf16 v[196:199], a[72:75], a[192:195], v[196:199]
    v_mfma_f32_16x16x32_bf16 v[236:239], a[76:79], a[192:195], v[236:239]
    s_waitcnt lgkmcnt(4)
    ds_read_b64_tr_b16 a[174:175], v95 offset:34816
    s_add_u32 s31, s98, 4096
    v_mfma_f32_16x16x32_bf16 v[196:199], a[112:115], a[196:199], v[196:199]
    buffer_load_dwordx4 v64, s[16:19], s31 offen offset:1024 sc0 sc1 lds
    v_mfma_f32_16x16x32_bf16 v[196:199], a[120:123], a[200:203], v[196:199]
    v_mfma_f32_16x16x32_bf16 v[196:199], a[128:131], v[228:231], v[196:199]
    s_waitcnt vmcnt(9)
    ds_read_b128 v[104:107], v65 offset:9216
    v_mfma_f32_16x16x32_bf16 v[236:239], a[116:119], a[196:199], v[236:239]
    s_barrier
    v_mfma_f32_16x16x32_bf16 v[236:239], a[124:127], a[200:203], v[236:239]
    buffer_load_dwordx4 v64, s[16:19], s31 offen offset:0 sc0 sc1 lds
    v_mfma_f32_16x16x32_bf16 v[236:239], a[132:135], v[228:231], v[236:239]
    s_add_u32 s31, s96, 6144
    ds_read_b128 v[28:31], v65 offset:10240
    s_waitcnt lgkmcnt(4)
    v_mfma_f32_16x16x32_bf16 v[196:199], a[136:139], v[8:11], v[196:199]
    ds_read_b128 v[24:27], v65 offset:3072
    v_mfma_f32_16x16x32_bf16 v[196:199], a[144:147], v[12:15], v[196:199]
    buffer_store_dwordx4 v[56:59], v64, s[16:19], s99 offen offset:3072 sc0 sc1
    ds_read_b128 a[212:215], v65 offset:6144
    v_mfma_f32_16x16x32_bf16 v[196:199], a[152:155], v[128:131], v[196:199]
    ds_read_b128 v[20:23], v65 offset:2048
    v_and_b32 v77, 1, v0
    v_mfma_f32_16x16x32_bf16 v[196:199], a[160:163], v[168:171], v[196:199]
    ds_read_b128 a[228:231], v65 offset:7168
    v_mfma_f32_16x16x32_bf16 v[236:239], a[140:143], v[8:11], v[236:239]
    ds_read_b128 a[192:195], v65 offset:11264
    s_waitcnt lgkmcnt(6)
    v_mfma_f32_16x16x32_bf16 v[196:199], a[168:171], v[104:107], v[196:199]
    ds_read_b128 v[228:231], v64 offset:16384
    v_lshlrev_b32 v76, 11, v1
    v_mfma_f32_16x16x32_bf16 v[236:239], a[148:151], v[12:15], v[236:239]
    v_mfma_f32_16x16x32_bf16 v[236:239], a[156:159], v[128:131], v[236:239]
    v_mfma_f32_16x16x32_bf16 v[196:199], a[176:179], v[144:147], v[196:199]
    ds_read_b128 a[200:203], v65 offset:15360
    v_mfma_f32_16x16x32_bf16 v[196:199], a[184:187], v[16:19], v[196:199]
    ds_read_b128 v[12:15], v64 offset:20480
    v_mfma_f32_16x16x32_bf16 v[236:239], a[164:167], v[168:171], v[236:239]
    ds_read_b128 a[196:199], v65 offset:14336
    v_lshl_add_u32 v76, v2, 3, v76
    v_mfma_f32_16x16x32_bf16 v[236:239], a[172:175], v[104:107], v[236:239]
    ds_read_b128 v[8:11], v64 offset:17408
    v_mfma_f32_16x16x32_bf16 v[236:239], a[180:183], v[144:147], v[236:239]
    ds_read_b128 v[144:147], v64 offset:28672
    v_mfma_f32_16x16x32_bf16 v[236:239], a[188:191], v[16:19], v[236:239]
    s_waitcnt lgkmcnt(7)
    v_cvt_pk_bf16_f32 v196, v196, v197
    v_cvt_pk_bf16_f32 v197, v198, v199
    v_mfma_f32_16x16x32_bf16 v[240:243], v[216:219], v[20:23], v[240:243]
    ds_read_b128 v[128:131], v64 offset:21504
    s_add_u32 m0, s27, 34816
    v_mfma_f32_16x16x32_bf16 v[200:203], v[176:179], v[20:23], v[200:203]
    ds_read_b128 v[104:107], v64 offset:25600
    v_mfma_f32_16x16x32_bf16 v[200:203], v[116:119], v[24:27], v[200:203]
    v_min_u32 v197, -2, v197
    v_mfma_f32_16x16x32_bf16 v[240:243], v[156:159], v[24:27], v[240:243]
    v_mfma_f32_16x16x32_bf16 v[240:243], v[220:223], a[212:215], v[240:243]
    v_cvt_pk_bf16_f32 v198, v236, v237
    v_cvt_pk_bf16_f32 v199, v238, v239
    v_mfma_f32_16x16x32_bf16 v[240:243], v[160:163], a[228:231], v[240:243]
    v_min_u32 v199, -2, v199
    v_mfma_f32_16x16x32_bf16 v[240:243], a[52:55], v[28:31], v[240:243]
    buffer_atomic_umax v74, v68, s[4:7], 0 offen sc0 sc1
    v_mfma_f32_16x16x32_bf16 v[200:203], v[180:183], a[212:215], v[200:203]
    s_waitcnt lgkmcnt(3)
    v_mfma_f32_16x16x32_bf16 v[240:243], a[60:63], a[192:195], v[240:243]
    v_min_u32 v198, -2, v198
    v_min_u32 v196, -2, v196
    v_mfma_f32_16x16x32_bf16 v[240:243], a[84:87], a[196:199], v[240:243]
    buffer_store_dwordx4 v[196:199], v64, s[16:19], s99 offen offset:0 sc0 sc1
    v_mfma_f32_16x16x32_bf16 v[200:203], v[120:123], a[228:231], v[200:203]
    ds_read_b128 v[168:171], v64 offset:24576
    v_add_u32 v80, s63, v76
    v_mfma_f32_16x16x32_bf16 v[240:243], a[92:95], a[200:203], v[240:243]
    ds_read_b128 v[16:19], v64 offset:29696
    v_mfma_f32_16x16x32_bf16 v[200:203], a[48:51], v[28:31], v[200:203]
    s_waitcnt vmcnt(9)
    v_cmp_lt_u32 s[12:13], 3, v75
    v_mfma_f32_16x16x32_bf16 v[240:243], a[100:103], v[228:231], v[240:243]
    s_andn2_b32 s14, s29, s12
    s_cbranch_scc1 L_sp3
L_rt3:
    ds_read_b128 v[24:27], v64 offset:19456
    v_mfma_f32_16x16x32_bf16 v[240:243], a[108:111], v[8:11], v[240:243]
    buffer_load_dwordx4 v64, s[16:19], s31 offen offset:0 sc0 sc1 lds
    v_mfma_f32_16x16x32_bf16 v[240:243], v[224:227], v[12:15], v[240:243]
    v_mfma_f32_16x16x32_bf16 v[200:203], a[56:59], a[192:195], v[200:203]
    v_mfma_f32_16x16x32_bf16 v[200:203], a[80:83], a[196:199], v[200:203]
    ds_read_b128 v[20:23], v64 offset:18432
    v_bfe_u32 v76, v0, 1, 4
    v_mfma_f32_16x16x32_bf16 v[200:203], a[88:91], a[200:203], v[200:203]
    buffer_load_dwordx4 v64, s[16:19], s31 offen offset:1024 sc0 sc1 lds
    v_mfma_f32_16x16x32_bf16 v[200:203], a[96:99], v[228:231], v[200:203]
    s_add_u32 s31, s97, 6144
    v_mfma_f32_16x16x32_bf16 v[200:203], a[104:107], v[8:11], v[200:203]
    s_waitcnt lgkmcnt(3)
    ds_read_b128 a[196:199], v64 offset:30720
    v_mfma_f32_16x16x32_bf16 v[240:243], v[164:167], v[128:131], v[240:243]
    ds_read_b128 v[28:31], v64 offset:26624
    s_add_u32 m0, s27, 98304
    v_mfma_f32_16x16x32_bf16 v[240:243], a[68:71], v[168:171], v[240:243]
    buffer_load_dwordx4 v64, s[16:19], s31 offen offset:1024 sc0 sc1 lds
    v_mfma_f32_16x16x32_bf16 v[200:203], v[184:187], v[12:15], v[200:203]
    ds_read_b128 a[228:231], v64 offset:23552
    v_mfma_f32_16x16x32_bf16 v[240:243], a[76:79], v[104:107], v[240:243]
    v_lshlrev_b32 v76, 11, v76
    v_mfma_f32_16x16x32_bf16 v[200:203], v[124:127], v[128:131], v[200:203]
    s_waitcnt lgkmcnt(4)
    v_mfma_f32_16x16x32_bf16 v[240:243], a[116:119], v[144:147], v[240:243]
    buffer_load_dwordx4 v64, s[16:19], s31 offen offset:0 sc0 sc1 lds
    v_mfma_f32_16x16x32_bf16 v[240:243], a[124:127], v[16:19], v[240:243]
    ds_read_b128 a[212:215], v64 offset:22528
    s_add_u32 m0, s27, 100352
    v_mfma_f32_16x16x32_bf16 v[200:203], a[64:67], v[168:171], v[200:203]
    s_waitcnt lgkmcnt(4)
    ds_read_b128 a[192:195], v64 offset:27648
    v_mfma_f32_16x16x32_bf16 v[240:243], a[132:135], v[20:23], v[240:243]
    s_add_u32 s31, s98, 6144
    ds_read_b128 a[200:203], v64 offset:31744
    v_mfma_f32_16x16x32_bf16 v[200:203], a[72:75], v[104:107], v[200:203]
    buffer_load_dwordx4 v64, s[16:19], s31 offen offset:0 sc0 sc1 lds
    v_mfma_f32_16x16x32_bf16 v[200:203], a[112:115], v[144:147], v[200:203]
    v_mfma_f32_16x16x32_bf16 v[200:203], a[120:123], v[16:19], v[200:203]
    s_waitcnt vmcnt(8)
    v_mfma_f32_16x16x32_bf16 v[200:203], a[128:131], v[20:23], v[200:203]
    s_barrier
    v_mfma_f32_16x16x32_bf16 v[240:243], a[140:143], v[24:27], v[240:243]
    buffer_load_dwordx4 v64, s[16:19], s31 offen offset:1024 sc0 sc1 lds
    v_mfma_f32_16x16x32_bf16 v[200:203], a[136:139], v[24:27], v[200:203]
    ds_read_b128 v[8:11], v65 offset:17408
    s_waitcnt lgkmcnt(3)
    v_mfma_f32_16x16x32_bf16 v[200:203], a[144:147], a[212:215], v[200:203]
    ds_read_b128 v[128:131], v65 offset:21504
    v_mfma_f32_16x16x32_bf16 v[200:203], a[152:155], a[228:231], v[200:203]
    ds_read_b128 v[228:231], v65 offset:16384
    v_mfma_f32_16x16x32_bf16 v[240:243], a[148:151], a[212:215], v[240:243]
    ds_read_b128 v[20:23], v65 offset:18432
    v_mfma_f32_16x16x32_bf16 v[240:243], a[156:159], a[228:231], v[240:243]
    v_mfma_f32_16x16x32_bf16 v[200:203], a[160:163], v[28:31], v[200:203]
    s_waitcnt lgkmcnt(4)
    ds_read_b128 v[168:171], v65 offset:24576
    v_mfma_f32_16x16x32_bf16 v[200:203], a[168:171], a[192:195], v[200:203]
    s_add_u32 m0, s27, 49152
    ds_read_b128 v[12:15], v65 offset:20480
    v_mfma_f32_16x16x32_bf16 v[240:243], a[164:167], v[28:31], v[240:243]
    ds_read_b128 v[144:147], v65 offset:28672
    v_mfma_f32_16x16x32_bf16 v[240:243], a[172:175], a[192:195], v[240:243]
    ds_read_b128 v[24:27], v65 offset:19456
    v_mfma_f32_16x16x32_bf16 v[200:203], a[176:179], a[196:199], v[200:203]
    ds_read_b128 v[28:31], v65 offset:26624
    v_mfma_f32_16x16x32_bf16 v[200:203], a[184:187], a[200:203], v[200:203]
    ds_read_b128 v[104:107], v65 offset:25600
    v_mfma_f32_16x16x32_bf16 v[240:243], a[180:183], a[196:199], v[240:243]
    v_mfma_f32_16x16x32_bf16 v[240:243], a[188:191], a[200:203], v[240:243]
    s_add_u32 s31, s96, 8192
    ds_read_b128 a[192:195], v65 offset:27648
    s_waitcnt lgkmcnt(8)
    v_mfma_f32_16x16x32_bf16 v[204:207], v[176:179], v[228:231], v[204:207]
    ds_read_b128 a[212:215], v65 offset:22528
    v_cvt_pk_bf16_f32 v200, v200, v201
    v_mfma_f32_16x16x32_bf16 v[244:247], v[216:219], v[228:231], v[244:247]
    v_cvt_pk_bf16_f32 v201, v202, v203
    v_min_u32 v200, -2, v200
    v_mfma_f32_16x16x32_bf16 v[244:247], v[156:159], v[8:11], v[244:247]
    v_cvt_pk_bf16_f32 v202, v240, v241
    v_min_u32 v201, -2, v201
    v_mfma_f32_16x16x32_bf16 v[204:207], v[116:119], v[8:11], v[204:207]
    s_waitcnt lgkmcnt(6)
    ds_read_b128 v[16:19], v65 offset:29696
    v_cvt_pk_bf16_f32 v203, v242, v243
    v_mfma_f32_16x16x32_bf16 v[204:207], v[180:183], v[12:15], v[204:207]
    v_min_u32 v202, -2, v202
    v_min_u32 v203, -2, v203
    v_mfma_f32_16x16x32_bf16 v[244:247], v[220:223], v[12:15], v[244:247]
    buffer_store_dwordx4 v[200:203], v64, s[16:19], s99 offen offset:1024 sc0 sc1
    ds_read_b128 v[8:11], v64 offset:33792
    v_mfma_f32_16x16x32_bf16 v[244:247], v[160:163], v[128:131], v[244:247]
    v_mfma_f32_16x16x32_bf16 v[244:247], a[52:55], v[168:171], v[244:247]
    s_waitcnt vmcnt(8) lgkmcnt(4)
    v_cmp_lt_u32 s[12:13], 4, v74
    v_mfma_f32_16x16x32_bf16 v[204:207], v[120:123], v[128:131], v[204:207]
    s_andn2_b32 s14, s29, s12
    s_cbranch_scc1 L_sp4
L_rt4:
    v_mfma_f32_16x16x32_bf16 v[204:207], a[48:51], v[168:171], v[204:207]
    buffer_load_dwordx4 v64, s[16:19], s31 offen offset:1024 sc0 sc1 lds
    v_mfma_f32_16x16x32_bf16 v[204:207], a[56:59], v[104:107], v[204:207]
    ds_read_b128 a[228:231], v65 offset:23552
    v_mfma_f32_16x16x32_bf16 v[204:207], a[80:83], v[144:147], v[204:207]
    s_waitcnt lgkmcnt(2)
    v_mfma_f32_16x16x32_bf16 v[204:207], a[88:91], v[16:19], v[204:207]
    v_lshl_add_u32 v76, v77, 5, v76
    v_mfma_f32_16x16x32_bf16 v[244:247], a[60:63], v[104:107], v[244:247]
    buffer_load_dwordx4 v64, s[16:19], s31 offen offset:0 sc0 sc1 lds
    v_mfma_f32_16x16x32_bf16 v[244:247], a[84:87], v[144:147], v[244:247]
    ds_read_b128 a[196:199], v65 offset:30720
    v_mfma_f32_16x16x32_bf16 v[204:207], a[96:99], v[20:23], v[204:207]
    ds_read_b128 v[144:147], v64 offset:45056
    v_mfma_f32_16x16x32_bf16 v[244:247], a[92:95], v[16:19], v[244:247]
    v_mfma_f32_16x16x32_bf16 v[204:207], a[104:107], v[24:27], v[204:207]
    s_add_u32 m0, s27, 51200
    s_add_u32 s31, s97, 8192
    ds_read_b128 a[200:203], v65 offset:31744
    v_mfma_f32_16x16x32_bf16 v[244:247], a[100:103], v[20:23], v[244:247]
    buffer_load_dwordx4 v64, s[16:19], s31 offen offset:1024 sc0 sc1 lds
    v_mfma_f32_16x16x32_bf16 v[244:247], a[108:111], v[24:27], v[244:247]
    v_mfma_f32_16x16x32_bf16 v[204:207], v[184:187], a[212:215], v[204:207]
    ds_read_b128 v[12:15], v64 offset:36864
    v_mfma_f32_16x16x32_bf16 v[244:247], v[224:227], a[212:215], v[244:247]
    s_waitcnt lgkmcnt(4)
    ds_read_b128 v[228:231], v64 offset:32768
    v_mfma_f32_16x16x32_bf16 v[244:247], v[164:167], a[228:231], v[244:247]
    ds_read_b128 v[104:107], v64 offset:41984
    v_mfma_f32_16x16x32_bf16 v[204:207], v[124:127], a[228:231], v[204:207]
    ds_read_b128 v[168:171], v64 offset:40960
    v_mfma_f32_16x16x32_bf16 v[204:207], a[64:67], v[28:31], v[204:207]
    buffer_load_dwordx4 v64, s[16:19], s31 offen offset:0 sc0 sc1 lds
    v_mfma_f32_16x16x32_bf16 v[204:207], a[72:75], a[192:195], v[204:207]
    s_waitcnt lgkmcnt(5)
    ds_read_b128 v[128:131], v64 offset:37888
    s_mov_b32 m0, s8
    v_mfma_f32_16x16x32_bf16 v[204:207], a[112:115], a[196:199], v[204:207]
    s_add_u32 s31, s98, 8192
    v_lshl_add_u32 v71, v0, 4, s61
    s_waitcnt lgkmcnt(5)
    v_mfma_f32_16x16x32_bf16 v[204:207], a[120:123], a[200:203], v[204:207]
    v_mfma_f32_16x16x32_bf16 v[244:247], a[68:71], v[28:31], v[244:247]
    buffer_load_dwordx4 v64, s[16:19], s31 offen offset:0 sc0 sc1 lds
    v_mfma_f32_16x16x32_bf16 v[244:247], a[76:79], a[192:195], v[244:247]
    ds_read_b128 v[16:19], v64 offset:46080
    v_mfma_f32_16x16x32_bf16 v[244:247], a[116:119], a[196:199], v[244:247]
    v_mfma_f32_16x16x32_bf16 v[244:247], a[124:127], a[200:203], v[244:247]
    s_waitcnt lgkmcnt(4)
    v_mfma_f32_16x16x32_bf16 v[244:247], a[132:135], v[228:231], v[244:247]
    buffer_load_dwordx4 v64, s[16:19], s31 offen offset:1024 sc0 sc1 lds
    v_mfma_f32_16x16x32_bf16 v[244:247], a[140:143], v[8:11], v[244:247]
    v_mfma_f32_16x16x32_bf16 v[204:207], a[128:131], v[228:231], v[204:207]
    s_waitcnt vmcnt(7)
    v_mfma_f32_16x16x32_bf16 v[204:207], a[136:139], v[8:11], v[204:207]
    s_barrier
    v_mfma_f32_16x16x32_bf16 v[204:207], a[144:147], v[12:15], v[204:207]
    ds_read_b128 a[212:215], v64 offset:38912
    v_lshrrev_b32 v77, 5, v0
    v_mfma_f32_16x16x32_bf16 v[244:247], a[148:151], v[12:15], v[244:247]
    s_waitcnt lgkmcnt(2)
    v_lshl_add_u32 v72, v0, 3, s62
    v_lshl_add_u32 v76, v77, 3, v76
    v_mfma_f32_16x16x32_bf16 v[204:207], a[152:155], v[128:131], v[204:207]
    ds_read_b128 v[20:23], v64 offset:34816
    v_mfma_f32_16x16x32_bf16 v[204:207], a[160:163], v[168:171], v[204:207]
    ds_read_b128 v[24:27], v64 offset:35840
    v_mfma_f32_16x16x32_bf16 v[204:207], a[168:171], v[104:107], v[204:207]
    ds_read_b128 a[196:199], v64 offset:47104
    v_mfma_f32_16x16x32_bf16 v[244:247], a[156:159], v[128:131], v[244:247]
    ds_read_b128 a[228:231], v64 offset:39936
    v_mfma_f32_16x16x32_bf16 v[204:207], a[176:179], v[144:147], v[204:207]
    s_waitcnt lgkmcnt(5)
    ds_read_b128 a[192:195], v64 offset:44032
    v_mfma_f32_16x16x32_bf16 v[204:207], a[184:187], v[16:19], v[204:207]
    ds_read_b128 v[28:31], v64 offset:43008
    v_mfma_f32_16x16x32_bf16 v[244:247], a[164:167], v[168:171], v[244:247]
    v_mfma_f32_16x16x32_bf16 v[244:247], a[172:175], v[104:107], v[244:247]
    ds_read_b128 a[200:203], v64 offset:48128
    v_mfma_f32_16x16x32_bf16 v[244:247], a[180:183], v[144:147], v[244:247]
    ds_read_b128 v[12:15], v65 offset:36864
    v_mfma_f32_16x16x32_bf16 v[244:247], a[188:191], v[16:19], v[244:247]
    s_nop 0
    v_cvt_pk_bf16_f32 v204, v204, v205
    s_waitcnt lgkmcnt(7)
    v_mfma_f32_16x16x32_bf16 v[248:251], v[216:219], v[20:23], v[248:251]
    v_cvt_pk_bf16_f32 v205, v206, v207
    s_waitcnt lgkmcnt(6)
    v_mfma_f32_16x16x32_bf16 v[248:251], v[156:159], v[24:27], v[248:251]
    s_nop 0
    v_cvt_pk_bf16_f32 v207, v246, v247
    v_min_u32 v205, -2, v205
    v_mfma_f32_16x16x32_bf16 v[248:251], v[220:223], a[212:215], v[248:251]
    s_waitcnt lgkmcnt(4)
    v_mfma_f32_16x16x32_bf16 v[248:251], v[160:163], a[228:231], v[248:251]
    ds_read_b128 v[8:11], v65 offset:33792
    v_min_u32 v204, -2, v204
    v_mfma_f32_16x16x32_bf16 v[208:211], v[176:179], v[20:23], v[208:211]
    v_cvt_pk_bf16_f32 v206, v244, v245
    v_mfma_f32_16x16x32_bf16 v[208:211], v[116:119], v[24:27], v[208:211]
    s_waitcnt lgkmcnt(3)
    v_min_u32 v207, -2, v207
    v_min_u32 v206, -2, v206
    v_mfma_f32_16x16x32_bf16 v[248:251], a[52:55], v[28:31], v[248:251]
    ds_read_b128 v[228:231], v65 offset:32768
    v_mfma_f32_16x16x32_bf16 v[208:211], v[180:183], a[212:215], v[208:211]
    buffer_store_dwordx4 v[204:207], v64, s[16:19], s99 offen offset:2048 sc0 sc1
    v_mfma_f32_16x16x32_bf16 v[248:251], a[60:63], a[192:195], v[248:251]
    ds_read_b128 v[168:171], v65 offset:40960
    v_mfma_f32_16x16x32_bf16 v[248:251], a[84:87], a[196:199], v[248:251]
    v_mfma_f32_16x16x32_bf16 v[208:211], v[120:123], a[228:231], v[208:211]
    ds_read_b128 v[128:131], v65 offset:37888
    v_mfma_f32_16x16x32_bf16 v[208:211], a[48:51], v[28:31], v[208:211]
    s_waitcnt lgkmcnt(4)
    ds_read_b128 v[104:107], v65 offset:41984
    v_mfma_f32_16x16x32_bf16 v[248:251], a[92:95], a[200:203], v[248:251]
    ds_read_b128 v[16:19], v65 offset:46080
    v_mfma_f32_16x16x32_bf16 v[208:211], a[56:59], a[192:195], v[208:211]
    v_mfma_f32_16x16x32_bf16 v[208:211], a[80:83], a[196:199], v[208:211]
    ds_read_b128 v[24:27], v65 offset:35840
    v_mfma_f32_16x16x32_bf16 v[208:211], a[88:91], a[200:203], v[208:211]
    s_waitcnt lgkmcnt(5)
    v_mfma_f32_16x16x32_bf16 v[248:251], a[100:103], v[228:231], v[248:251]
    ds_read_b128 v[144:147], v65 offset:45056
    v_mfma_f32_16x16x32_bf16 v[208:211], a[96:99], v[228:231], v[208:211]
    ds_read_b128 v[20:23], v65 offset:34816
    v_mfma_f32_16x16x32_bf16 v[248:251], a[108:111], v[8:11], v[248:251]
    v_mfma_f32_16x16x32_bf16 v[248:251], v[224:227], v[12:15], v[248:251]
    ds_read_b128 v[28:31], v65 offset:43008
    s_waitcnt lgkmcnt(6)
    v_mfma_f32_16x16x32_bf16 v[248:251], v[164:167], v[128:131], v[248:251]
    v_mfma_f32_16x16x32_bf16 v[248:251], a[68:71], v[168:171], v[248:251]
    ds_read_b128 a[228:231], v65 offset:39936
    v_mfma_f32_16x16x32_bf16 v[208:211], a[104:107], v[8:11], v[208:211]
    s_waitcnt vmcnt(7)
    v_mfma_f32_16x16x32_bf16 v[208:211], v[184:187], v[12:15], v[208:211]
    s_mov_b64 exec, 1
    global_atomic_umax v69, v70, s[24:25] sc1
    s_mov_b64 exec, -1
    v_mfma_f32_16x16x32_bf16 v[208:211], v[124:127], v[128:131], v[208:211]
    s_waitcnt lgkmcnt(4)
    ds_read_b128 a[212:215], v65 offset:38912
    v_mfma_f32_16x16x32_bf16 v[248:251], a[76:79], v[104:107], v[248:251]
    s_waitcnt lgkmcnt(4)
    v_mfma_f32_16x16x32_bf16 v[248:251], a[116:119], v[144:147], v[248:251]
    v_add_u32 v81, s32, v76
    v_mfma_f32_16x16x32_bf16 v[248:251], a[124:127], v[16:19], v[248:251]
    ds_read_b128 a[196:199], v65 offset:47104
    v_mfma_f32_16x16x32_bf16 v[208:211], a[64:67], v[168:171], v[208:211]
    s_waitcnt lgkmcnt(4)
    ds_read_b128 a[200:203], v65 offset:48128
    v_and_b32 v76, 3, v0
    v_mfma_f32_16x16x32_bf16 v[248:251], a[132:135], v[20:23], v[248:251]
    v_xor_b32 v77, s2, v76
    v_lshl_add_u32 v76, v77, 2, v76
    v_mfma_f32_16x16x32_bf16 v[208:211], a[72:75], v[104:107], v[208:211]
    v_mfma_f32_16x16x32_bf16 v[208:211], a[112:115], v[144:147], v[208:211]
    s_waitcnt vmcnt(2)
    ds_read_b128 a[192:195], v65 offset:44032
    v_mfma_f32_16x16x32_bf16 v[208:211], a[120:123], v[16:19], v[208:211]
    s_barrier
    v_mfma_f32_16x16x32_bf16 v[248:251], a[140:143], v[24:27], v[248:251]
    v_mfma_f32_16x16x32_bf16 v[208:211], a[128:131], v[20:23], v[208:211]
    s_waitcnt lgkmcnt(3)
    v_mfma_f32_16x16x32_bf16 v[248:251], a[148:151], a[212:215], v[248:251]
    ds_read_b128 v[228:231], v64 offset:49152
    v_mfma_f32_16x16x32_bf16 v[208:211], a[136:139], v[24:27], v[208:211]
    ds_read_b128 v[12:15], v64 offset:53248
    v_mfma_f32_16x16x32_bf16 v[248:251], a[156:159], a[228:231], v[248:251]
    ds_read_b128 v[8:11], v64 offset:50176
    v_mfma_f32_16x16x32_bf16 v[208:211], a[144:147], a[212:215], v[208:211]
    ds_read_b128 v[144:147], v64 offset:61440
    v_mfma_f32_16x16x32_bf16 v[248:251], a[164:167], v[28:31], v[248:251]
    v_mfma_f32_16x16x32_bf16 v[208:211], a[152:155], a[228:231], v[208:211]
    ds_read_b128 v[168:171], v64 offset:57344
    v_mfma_f32_16x16x32_bf16 v[208:211], a[160:163], v[28:31], v[208:211]
    s_waitcnt lgkmcnt(5)
    ds_read_b128 v[128:131], v64 offset:54272
    v_mfma_f32_16x16x32_bf16 v[208:211], a[168:171], a[192:195], v[208:211]
    ds_read_b128 v[104:107], v64 offset:58368
    v_mfma_f32_16x16x32_bf16 v[208:211], a[176:179], a[196:199], v[208:211]
    ds_read_b128 v[28:31], v64 offset:59392
    v_mfma_f32_16x16x32_bf16 v[208:211], a[184:187], a[200:203], v[208:211]
    ds_read_b128 v[16:19], v64 offset:62464
    v_mfma_f32_16x16x32_bf16 v[248:251], a[172:175], a[192:195], v[248:251]
    v_mfma_f32_16x16x32_bf16 v[248:251], a[180:183], a[196:199], v[248:251]
    s_waitcnt lgkmcnt(7)
    ds_read_b128 a[192:195], v64 offset:60416
    v_mul_u32_u24 v73, 5120, v76
    v_mfma_f32_16x16x32_bf16 v[252:255], v[216:219], v[228:231], v[252:255]
    s_waitcnt lgkmcnt(7)
    ds_read_b128 v[20:23], v64 offset:51200
    v_mfma_f32_16x16x32_bf16 v[252:255], v[156:159], v[8:11], v[252:255]
    buffer_atomic_umax v75, v68, s[4:7], 0 offen sc0 sc1
    v_mfma_f32_16x16x32_bf16 v[212:215], v[176:179], v[228:231], v[212:215]
    v_mfma_f32_16x16x32_bf16 v[248:251], a[188:191], a[200:203], v[248:251]
    ds_read_b128 a[196:199], v64 offset:63488
    v_mfma_f32_16x16x32_bf16 v[252:255], v[220:223], v[12:15], v[252:255]
    s_waitcnt lgkmcnt(6)
    ds_read_b128 v[24:27], v64 offset:52224
    v_mfma_f32_16x16x32_bf16 v[252:255], v[160:163], v[128:131], v[252:255]
    v_cvt_pk_bf16_f32 v208, v208, v209
    v_cvt_pk_bf16_f32 v209, v210, v211
    v_mfma_f32_16x16x32_bf16 v[252:255], a[52:55], v[168:171], v[252:255]
    s_waitcnt lgkmcnt(5)
    v_cvt_pk_bf16_f32 v211, v250, v251
    v_min_u32 v211, -2, v211
    v_mfma_f32_16x16x32_bf16 v[252:255], a[60:63], v[104:107], v[252:255]
    v_cvt_pk_bf16_f32 v210, v248, v249
    v_mfma_f32_16x16x32_bf16 v[212:215], v[116:119], v[8:11], v[212:215]
    ds_read_b128 a[200:203], v64 offset:64512
    v_min_u32 v210, -2, v210
    v_mfma_f32_16x16x32_bf16 v[212:215], v[180:183], v[12:15], v[212:215]
    ds_read_b128 a[212:215], v64 offset:55296
    v_min_u32 v209, -2, v209
    v_mfma_f32_16x16x32_bf16 v[252:255], a[84:87], v[144:147], v[252:255]
    s_waitcnt lgkmcnt(4)
    ds_read_b128 a[228:231], v64 offset:56320
    v_min_u32 v208, -2, v208
    v_mfma_f32_16x16x32_bf16 v[252:255], a[92:95], v[16:19], v[252:255]
    buffer_store_dwordx4 v[208:211], v64, s[16:19], s99 offen offset:3072 sc0 sc1
    v_mfma_f32_16x16x32_bf16 v[212:215], v[120:123], v[128:131], v[212:215]
    v_mfma_f32_16x16x32_bf16 v[252:255], a[100:103], v[20:23], v[252:255]
    v_mfma_f32_16x16x32_bf16 v[212:215], a[48:51], v[168:171], v[212:215]
    s_waitcnt lgkmcnt(3)
    v_mfma_f32_16x16x32_bf16 v[252:255], a[108:111], v[24:27], v[252:255]
    v_mfma_f32_16x16x32_bf16 v[212:215], a[56:59], v[104:107], v[212:215]
    v_mfma_f32_16x16x32_bf16 v[212:215], a[80:83], v[144:147], v[212:215]
    v_mfma_f32_16x16x32_bf16 v[212:215], a[88:91], v[16:19], v[212:215]
    ds_read_b128 v[128:131], v65 offset:62464
    v_mfma_f32_16x16x32_bf16 v[212:215], a[96:99], v[20:23], v[212:215]
    ds_read_b128 v[228:231], v65 offset:49152
    v_mfma_f32_16x16x32_bf16 v[212:215], a[104:107], v[24:27], v[212:215]
    s_waitcnt lgkmcnt(2)
    ds_read_b128 v[104:107], v66 offset:9216
    v_mfma_f32_16x16x32_bf16 v[252:255], v[224:227], a[212:215], v[252:255]
    v_mfma_f32_16x16x32_bf16 v[252:255], v[164:167], a[228:231], v[252:255]
    ds_read_b128 v[12:15], v65 offset:61440
    v_mfma_f32_16x16x32_bf16 v[212:215], v[184:187], a[212:215], v[212:215]
    ds_read_b128 v[168:171], v66 offset:8192
    v_mfma_f32_16x16x32_bf16 v[212:215], v[124:127], a[228:231], v[212:215]
    ds_read_b128 v[144:147], v66 offset:20480
    v_mfma_f32_16x16x32_bf16 v[252:255], a[68:71], v[28:31], v[252:255]
    ds_read_b128 v[8:11], v65 offset:50176
    v_mfma_f32_16x16x32_bf16 v[212:215], a[64:67], v[28:31], v[212:215]
    v_mfma_f32_16x16x32_bf16 v[252:255], a[76:79], a[192:195], v[252:255]
    v_mfma_f32_16x16x32_bf16 v[212:215], a[72:75], a[192:195], v[212:215]
    v_mfma_f32_16x16x32_bf16 v[252:255], a[116:119], a[196:199], v[252:255]
    v_mfma_f32_16x16x32_bf16 v[212:215], a[112:115], a[196:199], v[212:215]
    ds_read_b128 v[16:19], v66 offset:21504
    v_mfma_f32_16x16x32_bf16 v[252:255], a[124:127], a[200:203], v[252:255]
    v_mfma_f32_16x16x32_bf16 v[212:215], a[120:123], a[200:203], v[212:215]
    s_waitcnt lgkmcnt(4)
    v_mfma_f32_16x16x32_bf16 v[212:215], a[128:131], v[228:231], v[212:215]
    v_mfma_f32_16x16x32_bf16 v[252:255], a[132:135], v[228:231], v[252:255]
    s_waitcnt lgkmcnt(1)
    v_mfma_f32_16x16x32_bf16 v[212:215], a[136:139], v[8:11], v[212:215]
    v_mfma_f32_16x16x32_bf16 v[212:215], a[144:147], v[12:15], v[212:215]
    v_mfma_f32_16x16x32_bf16 v[212:215], a[152:155], v[128:131], v[212:215]
    v_mfma_f32_16x16x32_bf16 v[252:255], a[140:143], v[8:11], v[252:255]
    v_mfma_f32_16x16x32_bf16 v[212:215], a[160:163], v[168:171], v[212:215]
    v_mfma_f32_16x16x32_bf16 v[212:215], a[168:171], v[104:107], v[212:215]
    v_mfma_f32_16x16x32_bf16 v[212:215], a[176:179], v[144:147], v[212:215]
    s_waitcnt lgkmcnt(0)
    v_add_u32 v73, s59, v73
    v_mfma_f32_16x16x32_bf16 v[212:215], a[184:187], v[16:19], v[212:215]
    v_mfma_f32_16x16x32_bf16 v[252:255], a[148:151], v[12:15], v[252:255]
    v_mfma_f32_16x16x32_bf16 v[252:255], a[156:159], v[128:131], v[252:255]
    v_mfma_f32_16x16x32_bf16 v[252:255], a[164:167], v[168:171], v[252:255]
    v_mfma_f32_16x16x32_bf16 v[252:255], a[172:175], v[104:107], v[252:255]
    v_mfma_f32_16x16x32_bf16 v[252:255], a[180:183], v[144:147], v[252:255]
    v_mfma_f32_16x16x32_bf16 v[252:255], a[188:191], v[16:19], v[252:255]
    s_nop 1
    v_cvt_pk_bf16_f32 v212, v212, v213
    v_cvt_pk_bf16_f32 v213, v214, v215
    v_min_u32 v213, -2, v213
    v_min_u32 v212, -2, v212
    s_nop 1
    v_cvt_pk_bf16_f32 v214, v252, v253
    v_min_u32 v214, -2, v214
    v_cvt_pk_bf16_f32 v215, v254, v255
    v_min_u32 v215, -2, v215
    buffer_store_dwordx4 v[212:215], v64, s[16:19], s28 offen offset:0 sc0 sc1
    s_waitcnt vmcnt(2)
    v_cmp_lt_u32 s[12:13], 0, v75
    s_andn2_b32 s14, 15, s12
    s_cbranch_scc1 L_sp5
L_rt5:
    buffer_load_dword v4, v73, s[16:19], 0 offen sc0 sc1
    buffer_load_dwordx4 v[108:111], v71, s[16:19], s40 offen sc0 sc1
    buffer_load_dwordx4 v[148:151], v71, s[16:19], s41 offen sc0 sc1
    buffer_load_dwordx4 v[112:115], v71, s[16:19], s42 offen sc0 sc1
    buffer_load_dwordx4 v[152:155], v71, s[16:19], s43 offen sc0 sc1
    s_nop 15
    s_nop 15
    s_nop 15
    s_nop 2
    buffer_load_dwordx2 v[96:97], v72, s[16:19], s40 offen sc0 sc1
    buffer_load_dwordx2 v[98:99], v72, s[16:19], s41 offen sc0 sc1
    buffer_load_dwordx2 v[100:101], v72, s[16:19], s42 offen sc0 sc1
    buffer_load_dwordx2 v[102:103], v72, s[16:19], s43 offen sc0 sc1
    s_waitcnt vmcnt(4)
    v_max3_u32 v3, v108, v109, 0
    v_max3_u32 v3, v110, v111, v3
    v_max3_u32 v3, v148, v149, v3
    v_max3_u32 v3, v150, v151, v3
    v_max3_u32 v3, v112, v113, v3
    v_max3_u32 v3, v114, v115, v3
    v_max3_u32 v3, v152, v153, v3
    v_max3_u32 v3, v154, v155, v3
    v_cmp_eq_u32 vcc, -1, v3
    s_cbranch_vccnz L_gp
    v_cmp_eq_u32 vcc, -1, v4
    buffer_load_dwordx2 v[40:41], v72, s[16:19], s40 offen sc0 sc1
    buffer_load_dwordx2 v[42:43], v72, s[16:19], s41 offen sc0 sc1
    buffer_load_dwordx2 v[44:45], v72, s[16:19], s42 offen sc0 sc1
    buffer_load_dwordx2 v[46:47], v72, s[16:19], s43 offen sc0 sc1
    v_lshlrev_b32 v132, 16, v108
    v_and_b32 v133, 0xffff0000, v108
    v_lshlrev_b32 v134, 16, v109
    v_and_b32 v135, 0xffff0000, v109
    v_lshlrev_b32 v172, 16, v110
    v_and_b32 v173, 0xffff0000, v110
    v_lshlrev_b32 v174, 16, v111
    v_and_b32 v175, 0xffff0000, v111
    v_lshlrev_b32 v52, 16, v148
    v_and_b32 v53, 0xffff0000, v148
    v_add_f32 v132, v132, v52
    v_add_f32 v133, v133, v53
    v_lshlrev_b32 v54, 16, v149
    v_and_b32 v55, 0xffff0000, v149
    v_add_f32 v134, v134, v54
    v_add_f32 v135, v135, v55
    v_lshlrev_b32 v52, 16, v150
    v_and_b32 v53, 0xffff0000, v150
    v_add_f32 v172, v172, v52
    v_add_f32 v173, v173, v53
    v_lshlrev_b32 v54, 16, v151
    v_and_b32 v55, 0xffff0000, v151
    v_add_f32 v174, v174, v54
    v_add_f32 v175, v175, v55
    v_lshlrev_b32 v52, 16, v112
    v_and_b32 v53, 0xffff0000, v112
    v_add_f32 v132, v132, v52
    v_add_f32 v133, v133, v53
    v_lshlrev_b32 v54, 16, v113
    v_and_b32 v55, 0xffff0000, v113
    v_add_f32 v134, v134, v54
    v_add_f32 v135, v135, v55
    v_lshlrev_b32 v52, 16, v114
    v_and_b32 v53, 0xffff0000, v114
    v_add_f32 v172, v172, v52
    v_add_f32 v173, v173, v53
    v_lshlrev_b32 v54, 16, v115
    v_and_b32 v55, 0xffff0000, v115
    v_add_f32 v174, v174, v54
    v_add_f32 v175, v175, v55
    v_lshlrev_b32 v52, 16, v152
    v_and_b32 v53, 0xffff0000, v152
    v_add_f32 v132, v132, v52
    v_add_f32 v133, v133, v53
    v_lshlrev_b32 v54, 16, v153
    v_and_b32 v55, 0xffff0000, v153
    v_add_f32 v134, v134, v54
    v_add_f32 v135, v135, v55
    v_lshlrev_b32 v52, 16, v154
    v_and_b32 v53, 0xffff0000, v154
    v_add_f32 v172, v172, v52
    v_add_f32 v173, v173, v53
    v_lshlrev_b32 v54, 16, v155
    v_and_b32 v55, 0xffff0000, v155
    v_add_f32 v174, v174, v54
    v_add_f32 v175, v175, v55
    v_cvt_pk_bf16_f32 v192, v132, v133
    v_cvt_pk_bf16_f32 v193, v134, v135
    v_cvt_pk_bf16_f32 v194, v172, v173
    v_cvt_pk_bf16_f32 v195, v174, v175
    s_cmp_eq_u32 s26, 3
    s_cselect_b64 s[44:45], 0, -1
    s_cbranch_vccnz L_gq
L_g2:
    s_waitcnt vmcnt(4)
    v_max3_u32 v3, v96, v97, v98
    v_max3_u32 v7, v99, v100, v101
    v_max3_u32 v3, v3, v102, v103
    v_max_u32 v3, v3, v7
    v_cmp_eq_u32 vcc, -1, v3
    s_cbranch_vccz L_h0
    buffer_load_dwordx2 v[96:97], v72, s[16:19], s40 offen sc0 sc1
    buffer_load_dwordx2 v[98:99], v72, s[16:19], s41 offen sc0 sc1
    buffer_load_dwordx2 v[100:101], v72, s[16:19], s42 offen sc0 sc1
    buffer_load_dwordx2 v[102:103], v72, s[16:19], s43 offen sc0 sc1
    s_waitcnt vmcnt(4)
    v_max3_u32 v3, v40, v41, v42
    v_max3_u32 v7, v43, v44, v45
    v_max3_u32 v3, v3, v46, v47
    v_max_u32 v3, v3, v7
    v_cmp_eq_u32 vcc, -1, v3
    s_cbranch_vccz L_h1
    buffer_load_dwordx2 v[40:41], v72, s[16:19], s40 offen sc0 sc1
    buffer_load_dwordx2 v[42:43], v72, s[16:19], s41 offen sc0 sc1
    buffer_load_dwordx2 v[44:45], v72, s[16:19], s42 offen sc0 sc1
    buffer_load_dwordx2 v[46:47], v72, s[16:19], s43 offen sc0 sc1
    s_add_u32 s39, s39, 1
    s_cmp_le_u32 s39, 200000
    s_cbranch_scc1 L_g2
    s_branch L_end
L_gp:
    buffer_load_dword v4, v73, s[16:19], 0 offen sc0 sc1
    s_add_u32 s39, s39, 1
    s_cmp_gt_u32 s39, 200000
    s_cbranch_scc1 L_end
    s_waitcnt vmcnt(0)
    v_cmp_eq_u32 vcc, -1, v4
    s_cbranch_vccnz L_gp
    s_branch L_rt5
L_gq:
    buffer_load_dword v4, v73, s[16:19], 0 offen sc0 sc1
    s_add_u32 s39, s39, 1
    s_cmp_gt_u32 s39, 200000
    s_cbranch_scc1 L_end
    s_waitcnt vmcnt(0)
    v_cmp_eq_u32 vcc, -1, v4
    s_cbranch_vccnz L_gq
    buffer_load_dwordx2 v[96:97], v72, s[16:19], s40 offen sc0 sc1
    buffer_load_dwordx2 v[98:99], v72, s[16:19], s41 offen sc0 sc1
    buffer_load_dwordx2 v[100:101], v72, s[16:19], s42 offen sc0 sc1
    buffer_load_dwordx2 v[102:103], v72, s[16:19], s43 offen sc0 sc1
    s_nop 15
    s_nop 15
    s_nop 15
    s_nop 2
    buffer_load_dwordx2 v[40:41], v72, s[16:19], s40 offen sc0 sc1
    buffer_load_dwordx2 v[42:43], v72, s[16:19], s41 offen sc0 sc1
    buffer_load_dwordx2 v[44:45], v72, s[16:19], s42 offen sc0 sc1
    buffer_load_dwordx2 v[46:47], v72, s[16:19], s43 offen sc0 sc1
    s_branch L_g2
L_h1:
    v_lshlrev_b32 v8, 16, v40
    v_and_b32 v9, 0xffff0000, v40
    v_lshlrev_b32 v10, 16, v41
    v_and_b32 v11, 0xffff0000, v41
    v_lshlrev_b32 v20, 16, v42
    v_and_b32 v21, 0xffff0000, v42
    v_pk_add_f32 v[8:9], v[8:9], v[20:21]
    v_lshlrev_b32 v22, 16, v43
    v_and_b32 v23, 0xffff0000, v43
    v_pk_add_f32 v[10:11], v[10:11], v[22:23]
    v_lshlrev_b32 v20, 16, v44
    v_and_b32 v21, 0xffff0000, v44
    v_pk_add_f32 v[8:9], v[8:9], v[20:21]
    v_lshlrev_b32 v22, 16, v45
    v_and_b32 v23, 0xffff0000, v45
    v_pk_add_f32 v[10:11], v[10:11], v[22:23]
    v_lshlrev_b32 v20, 16, v46
    v_and_b32 v21, 0xffff0000, v46
    v_pk_add_f32 v[8:9], v[8:9], v[20:21]
    v_lshlrev_b32 v22, 16, v47
    v_and_b32 v23, 0xffff0000, v47
    v_pk_add_f32 v[10:11], v[10:11], v[22:23]
    v_cvt_pk_bf16_f32 v28, v8, v9
    v_cvt_pk_bf16_f32 v29, v10, v11
    global_store_dwordx2 v81, v[28:29], s[100:101]
    s_mov_b64 exec, s[44:45]
    global_store_dwordx2 v80, v[192:193], s[100:101]
    global_store_dwordx2 v80, v[194:195], s[100:101] offset:32
    s_endpgm
L_h0:
    v_lshlrev_b32 v8, 16, v96
    v_and_b32 v9, 0xffff0000, v96
    v_lshlrev_b32 v10, 16, v97
    v_and_b32 v11, 0xffff0000, v97
    v_lshlrev_b32 v20, 16, v98
    v_and_b32 v21, 0xffff0000, v98
    v_pk_add_f32 v[8:9], v[8:9], v[20:21]
    v_lshlrev_b32 v22, 16, v99
    v_and_b32 v23, 0xffff0000, v99
    v_pk_add_f32 v[10:11], v[10:11], v[22:23]
    v_lshlrev_b32 v20, 16, v100
    v_and_b32 v21, 0xffff0000, v100
    v_pk_add_f32 v[8:9], v[8:9], v[20:21]
    v_lshlrev_b32 v22, 16, v101
    v_and_b32 v23, 0xffff0000, v101
    v_pk_add_f32 v[10:11], v[10:11], v[22:23]
    v_lshlrev_b32 v20, 16, v102
    v_and_b32 v21, 0xffff0000, v102
    v_pk_add_f32 v[8:9], v[8:9], v[20:21]
    v_lshlrev_b32 v22, 16, v103
    v_and_b32 v23, 0xffff0000, v103
    v_pk_add_f32 v[10:11], v[10:11], v[22:23]
    v_cvt_pk_bf16_f32 v28, v8, v9
    v_cvt_pk_bf16_f32 v29, v10, v11
    global_store_dwordx2 v81, v[28:29], s[100:101]
    s_mov_b64 exec, s[44:45]
    global_store_dwordx2 v80, v[192:193], s[100:101]
    global_store_dwordx2 v80, v[194:195], s[100:101] offset:32
L_h:
L_end:
    s_endpgm
L_sp0:
    buffer_atomic_umax v74, v68, s[4:7], 0 offen sc0 sc1
    s_waitcnt vmcnt(0)
    v_cmp_lt_u32 s[12:13], 0, v74
    s_andn2_b32 s14, s29, s12
    s_cbranch_scc0 L_rt0
    s_add_u32 s39, s39, 1
    s_cmp_le_u32 s39, 200000
    s_cbranch_scc1 L_sp0
    s_branch L_end
L_sp1:
    buffer_atomic_umax v75, v68, s[4:7], 0 offen sc0 sc1
    s_waitcnt vmcnt(0)
    v_cmp_lt_u32 s[12:13], 1, v75
    s_andn2_b32 s14, s29, s12
    s_cbranch_scc0 L_rt1
    s_add_u32 s39, s39, 1
    s_cmp_le_u32 s39, 200000
    s_cbranch_scc1 L_sp1
    s_branch L_end
L_sp2:
    buffer_atomic_umax v74, v68, s[4:7], 0 offen sc0 sc1
    s_waitcnt vmcnt(0)
    v_cmp_lt_u32 s[12:13], 2, v74
    s_andn2_b32 s14, s29, s12
    s_cbranch_scc0 L_rt2
    s_add_u32 s39, s39, 1
    s_cmp_le_u32 s39, 200000
    s_cbranch_scc1 L_sp2
    s_branch L_end
L_sp3:
    buffer_atomic_umax v75, v68, s[4:7], 0 offen sc0 sc1
    s_waitcnt vmcnt(0)
    v_cmp_lt_u32 s[12:13], 3, v75
    s_andn2_b32 s14, s29, s12
    s_cbranch_scc0 L_rt3
    s_add_u32 s39, s39, 1
    s_cmp_le_u32 s39, 200000
    s_cbranch_scc1 L_sp3
    s_branch L_end
L_sp4:
    buffer_atomic_umax v74, v68, s[4:7], 0 offen sc0 sc1
    s_waitcnt vmcnt(0)
    v_cmp_lt_u32 s[12:13], 4, v74
    s_andn2_b32 s14, s29, s12
    s_cbranch_scc0 L_rt4
    s_add_u32 s39, s39, 1
    s_cmp_le_u32 s39, 200000
    s_cbranch_scc1 L_sp4
    s_branch L_end
L_sp5:
    buffer_atomic_umax v75, v68, s[4:7], 0 offen sc0 sc1
    s_waitcnt vmcnt(0)
    v_cmp_lt_u32 s[12:13], 0, v75
    s_andn2_b32 s14, 15, s12
    s_cbranch_scc0 L_rt5
    s_add_u32 s39, s39, 1
    s_cmp_le_u32 s39, 200000
    s_cbranch_scc1 L_sp5
    s_branch L_end
L_fallback:
    s_mov_b32 s34, 1
    s_waitcnt vmcnt(0) lgkmcnt(0)
    s_nop 15
    s_lshl_b32 s3, s26, 6
    v_or_b32 v0, s3, v0
    s_barrier
    s_branch L_top
L_fb2:
    s_waitcnt vmcnt(0) lgkmcnt(0)
    s_nop 15
    s_barrier
    v_mov_b32 v56, 0xff800000
    v_mov_b32 v57, 0xff800000
    v_mov_b32 v58, 0xff800000
    v_mov_b32 v59, 0xff800000
    v_mov_b32 v60, 0xff800000
    s_mov_b32 s28, 0
L_fb_loop:
    s_add_u32 m0, s27, 0
    s_nop 0
    buffer_load_dwordx4 v76, s[4:7], s28 offen offset:0  lds
    buffer_load_dwordx4 v77, s[4:7], s28 offen offset:1024  lds
    buffer_load_dwordx4 v78, s[4:7], s28 offen offset:2048  lds
    buffer_load_dwordx4 v79, s[4:7], s28 offen offset:3072  lds
    s_add_u32 s28, s28, 16384
    s_waitcnt vmcnt(0)
    s_barrier
    ds_read_b128 a[80:83], v64 offset:0
    ds_read_b128 a[84:87], v65 offset:0
    ds_read_b128 a[88:91], v66 offset:0
    ds_read_b128 a[92:95], v67 offset:0
    ds_read_b128 a[96:99], v64 offset:4096
    ds_read_b128 a[100:103], v65 offset:4096
    ds_read_b128 a[104:107], v66 offset:4096
    ds_read_b128 a[108:111], v67 offset:4096
    s_waitcnt lgkmcnt(7)
    v_mfma_f32_16x16x32_bf16 v[96:99], a[80:83], a[0:3], 0
    s_waitcnt lgkmcnt(6)
    v_mfma_f32_16x16x32_bf16 v[96:99], a[84:87], a[4:7], v[96:99]
    s_waitcnt lgkmcnt(5)
    v_mfma_f32_16x16x32_bf16 v[96:99], a[88:91], a[8:11], v[96:99]
    s_waitcnt lgkmcnt(4)
    v_mfma_f32_16x16x32_bf16 v[96:99], a[92:95], a[12:15], v[96:99]
    s_waitcnt lgkmcnt(3)
    v_mfma_f32_16x16x32_bf16 v[100:103], a[96:99], a[0:3], 0
    s_waitcnt lgkmcnt(2)
    v_mfma_f32_16x16x32_bf16 v[100:103], a[100:103], a[4:7], v[100:103]
    s_waitcnt lgkmcnt(1)
    v_mfma_f32_16x16x32_bf16 v[100:103], a[104:107], a[8:11], v[100:103]
    s_waitcnt lgkmcnt(0)
    v_mfma_f32_16x16x32_bf16 v[100:103], a[108:111], a[12:15], v[100:103]
    v_mfma_f32_16x16x32_bf16 v[104:107], a[80:83], a[16:19], 0
    v_mfma_f32_16x16x32_bf16 v[104:107], a[84:87], a[20:23], v[104:107]
    v_mfma_f32_16x16x32_bf16 v[104:107], a[88:91], a[24:27], v[104:107]
    v_mfma_f32_16x16x32_bf16 v[104:107], a[92:95], a[28:31], v[104:107]
    v_mfma_f32_16x16x32_bf16 v[108:111], a[96:99], a[16:19], 0
    v_mfma_f32_16x16x32_bf16 v[108:111], a[100:103], a[20:23], v[108:111]
    v_mfma_f32_16x16x32_bf16 v[108:111], a[104:107], a[24:27], v[108:111]
    v_mfma_f32_16x16x32_bf16 v[108:111], a[108:111], a[28:31], v[108:111]
    v_mfma_f32_16x16x32_bf16 v[112:115], a[80:83], a[32:35], 0
    v_mfma_f32_16x16x32_bf16 v[112:115], a[84:87], a[36:39], v[112:115]
    v_mfma_f32_16x16x32_bf16 v[112:115], a[88:91], a[40:43], v[112:115]
    v_mfma_f32_16x16x32_bf16 v[112:115], a[92:95], a[44:47], v[112:115]
    v_mfma_f32_16x16x32_bf16 v[116:119], a[96:99], a[32:35], 0
    v_mfma_f32_16x16x32_bf16 v[116:119], a[100:103], a[36:39], v[116:119]
    v_mfma_f32_16x16x32_bf16 v[116:119], a[104:107], a[40:43], v[116:119]
    v_mfma_f32_16x16x32_bf16 v[116:119], a[108:111], a[44:47], v[116:119]
    v_mfma_f32_16x16x32_bf16 v[120:123], a[80:83], a[48:51], 0
    v_mfma_f32_16x16x32_bf16 v[120:123], a[84:87], a[52:55], v[120:123]
    v_mfma_f32_16x16x32_bf16 v[120:123], a[88:91], a[56:59], v[120:123]
    v_mfma_f32_16x16x32_bf16 v[120:123], a[92:95], a[60:63], v[120:123]
    v_mfma_f32_16x16x32_bf16 v[124:127], a[96:99], a[48:51], 0
    v_mfma_f32_16x16x32_bf16 v[124:127], a[100:103], a[52:55], v[124:127]
    v_mfma_f32_16x16x32_bf16 v[124:127], a[104:107], a[56:59], v[124:127]
    v_mfma_f32_16x16x32_bf16 v[124:127], a[108:111], a[60:63], v[124:127]
    v_mfma_f32_16x16x32_bf16 v[128:131], a[80:83], a[64:67], 0
    v_mfma_f32_16x16x32_bf16 v[128:131], a[84:87], a[68:71], v[128:131]
    v_mfma_f32_16x16x32_bf16 v[128:131], a[88:91], a[72:75], v[128:131]
    v_mfma_f32_16x16x32_bf16 v[128:131], a[92:95], a[76:79], v[128:131]
    v_mfma_f32_16x16x32_bf16 v[132:135], a[96:99], a[64:67], 0
    v_mfma_f32_16x16x32_bf16 v[132:135], a[100:103], a[68:71], v[132:135]
    v_mfma_f32_16x16x32_bf16 v[132:135], a[104:107], a[72:75], v[132:135]
    v_mfma_f32_16x16x32_bf16 v[132:135], a[108:111], a[76:79], v[132:135]
    v_max3_f32 v56, v56, v96, v97
    v_max3_f32 v56, v56, v98, v99
    v_max3_f32 v56, v56, v100, v101
    v_max3_f32 v56, v56, v102, v103
    v_max3_f32 v57, v57, v104, v105
    v_max3_f32 v57, v57, v106, v107
    v_max3_f32 v57, v57, v108, v109
    v_max3_f32 v57, v57, v110, v111
    v_max3_f32 v58, v58, v112, v113
    v_max3_f32 v58, v58, v114, v115
    v_max3_f32 v58, v58, v116, v117
    v_max3_f32 v58, v58, v118, v119
    v_max3_f32 v59, v59, v120, v121
    v_max3_f32 v59, v59, v122, v123
    v_max3_f32 v59, v59, v124, v125
    v_max3_f32 v59, v59, v126, v127
    v_max3_f32 v60, v60, v128, v129
    v_max3_f32 v60, v60, v130, v131
    v_max3_f32 v60, v60, v132, v133
    v_max3_f32 v60, v60, v134, v135
    s_cmp_lt_u32 s28, 0x80000
    s_barrier
    s_cbranch_scc1 L_fb_loop
    v_mov_b32 v8, v56
    v_mov_b32 v9, v57
    v_mov_b32 v10, v58
    v_mov_b32 v11, v59
    v_mov_b32 v12, v60
    v_permlane16_swap_b32 v56, v8
    v_permlane16_swap_b32 v57, v9
    v_permlane16_swap_b32 v58, v10
    v_permlane16_swap_b32 v59, v11
    v_permlane16_swap_b32 v60, v12
    v_max_f32 v56, v56, v8
    v_max_f32 v57, v57, v9
    v_max_f32 v58, v58, v10
    v_max_f32 v59, v59, v11
    v_max_f32 v60, v60, v12
    v_mov_b32 v8, v56
    v_mov_b32 v9, v57
    v_mov_b32 v10, v58
    v_mov_b32 v11, v59
    v_mov_b32 v12, v60
    v_permlane32_swap_b32 v56, v8
    v_permlane32_swap_b32 v57, v9
    v_permlane32_swap_b32 v58, v10
    v_permlane32_swap_b32 v59, v11
    v_permlane32_swap_b32 v60, v12
    v_max_f32 v56, v56, v8
    v_max_f32 v57, v57, v9
    v_max_f32 v58, v58, v10
    v_max_f32 v59, v59, v11
    v_max_f32 v60, v60, v12
    ds_write_b128 v91, v[56:59] offset:10240
    ds_write_b32 v91, v60 offset:11264
    s_mov_b32 s28, 0
    s_add_u32 m0, s27, 0
    s_nop 0
    buffer_load_dwordx4 v76, s[4:7], s28 offen offset:0 nt lds
    buffer_load_dwordx4 v77, s[4:7], s28 offen offset:1024 nt lds
    buffer_load_dwordx4 v78, s[4:7], s28 offen offset:2048 nt lds
    buffer_load_dwordx4 v79, s[4:7], s28 offen offset:3072 nt lds
    s_mov_b32 s28, 0
    s_add_u32 m0, s27, 65536
    s_nop 0
    buffer_load_dwordx4 v80, s[8:11], s28 offen offset:0 nt lds
    buffer_load_dwordx4 v81, s[8:11], s28 offen offset:1024 nt lds
    buffer_load_dwordx4 v80, s[8:11], s28 offen offset:2048 nt lds
    buffer_load_dwordx4 v81, s[8:11], s28 offen offset:3072 nt lds
    s_mov_b32 s28, 16384
    s_add_u32 m0, s27, 16384
    s_nop 0
    buffer_load_dwordx4 v76, s[4:7], s28 offen offset:0 nt lds
    buffer_load_dwordx4 v77, s[4:7], s28 offen offset:1024 nt lds
    buffer_load_dwordx4 v78, s[4:7], s28 offen offset:2048 nt lds
    buffer_load_dwordx4 v79, s[4:7], s28 offen offset:3072 nt lds
    s_mov_b32 s28, 16384
    s_add_u32 m0, s27, 81920
    s_nop 0
    buffer_load_dwordx4 v80, s[8:11], s28 offen offset:0 nt lds
    buffer_load_dwordx4 v81, s[8:11], s28 offen offset:1024 nt lds
    buffer_load_dwordx4 v80, s[8:11], s28 offen offset:2048 nt lds
    buffer_load_dwordx4 v81, s[8:11], s28 offen offset:3072 nt lds
    s_mov_b32 s28, 32768
    s_add_u32 m0, s27, 32768
    s_nop 0
    buffer_load_dwordx4 v76, s[4:7], s28 offen offset:0 nt lds
    buffer_load_dwordx4 v77, s[4:7], s28 offen offset:1024 nt lds
    buffer_load_dwordx4 v78, s[4:7], s28 offen offset:2048 nt lds
    buffer_load_dwordx4 v79, s[4:7], s28 offen offset:3072 nt lds
    s_mov_b32 s28, 32768
    s_add_u32 m0, s27, 98304
    s_nop 0
    buffer_load_dwordx4 v80, s[8:11], s28 offen offset:0 nt lds
    buffer_load_dwordx4 v81, s[8:11], s28 offen offset:1024 nt lds
    buffer_load_dwordx4 v80, s[8:11], s28 offen offset:2048 nt lds
    buffer_load_dwordx4 v81, s[8:11], s28 offen offset:3072 nt lds
    s_waitcnt vmcnt(0) lgkmcnt(0)
    s_barrier
    ds_read_b128 v[8:11], v90 offset:10240
    ds_read_b32 v12, v90 offset:11264
    ds_read_b128 a[80:83], v64 offset:0
    ds_read_b128 a[84:87], v65 offset:0
    ds_read_b128 a[88:91], v66 offset:0
    ds_read_b128 a[92:95], v67 offset:0
    ds_read_b128 a[96:99], v64 offset:4096
    ds_read_b128 a[100:103], v65 offset:4096
    ds_read_b128 a[104:107], v66 offset:4096
    ds_read_b128 a[108:111], v67 offset:4096
    ds_read_b64_tr_b16 a[144:145], v68 offset:0
    ds_read_b64_tr_b16 a[146:147], v68 offset:4096
    ds_read_b64_tr_b16 a[148:149], v69 offset:0
    ds_read_b64_tr_b16 a[150:151], v69 offset:4096
    ds_read_b64_tr_b16 a[152:153], v70 offset:0
    ds_read_b64_tr_b16 a[154:155], v70 offset:4096
    ds_read_b64_tr_b16 a[156:157], v71 offset:0
    ds_read_b64_tr_b16 a[158:159], v71 offset:4096
    ds_read_b64_tr_b16 a[160:161], v72 offset:0
    ds_read_b64_tr_b16 a[162:163], v72 offset:4096
    ds_read_b64_tr_b16 a[164:165], v73 offset:0
    ds_read_b64_tr_b16 a[166:167], v73 offset:4096
    ds_read_b64_tr_b16 a[168:169], v74 offset:0
    ds_read_b64_tr_b16 a[170:171], v74 offset:4096
    ds_read_b64_tr_b16 a[172:173], v75 offset:0
    ds_read_b64_tr_b16 a[174:175], v75 offset:4096
    s_waitcnt lgkmcnt(15)
    v_max_f32 v56, v56, v8
    v_sub_f32 v32, 0, v56
    v_sub_f32 v33, 0, v56
    v_sub_f32 v34, 0, v56
    v_sub_f32 v35, 0, v56
    v_max_f32 v57, v57, v9
    v_sub_f32 v36, 0, v57
    v_sub_f32 v37, 0, v57
    v_sub_f32 v38, 0, v57
    v_sub_f32 v39, 0, v57
    v_max_f32 v58, v58, v10
    v_sub_f32 v40, 0, v58
    v_sub_f32 v41, 0, v58
    v_sub_f32 v42, 0, v58
    v_sub_f32 v43, 0, v58
    v_max_f32 v59, v59, v11
    v_sub_f32 v44, 0, v59
    v_sub_f32 v45, 0, v59
    v_sub_f32 v46, 0, v59
    v_sub_f32 v47, 0, v59
    v_max_f32 v60, v60, v12
    v_sub_f32 v48, 0, v60
    v_sub_f32 v49, 0, v60
    v_sub_f32 v50, 0, v60
    v_sub_f32 v51, 0, v60
    v_mov_b32 v96, 0
    v_mov_b32 v97, 0
    v_mov_b32 v98, 0
    v_mov_b32 v99, 0
    v_mov_b32 v100, 0
    v_mov_b32 v101, 0
    v_mov_b32 v102, 0
    v_mov_b32 v103, 0
    v_mov_b32 v104, 0
    v_mov_b32 v105, 0
    v_mov_b32 v106, 0
    v_mov_b32 v107, 0
    v_mov_b32 v108, 0
    v_mov_b32 v109, 0
    v_mov_b32 v110, 0
    v_mov_b32 v111, 0
    v_mov_b32 v112, 0
    v_mov_b32 v113, 0
    v_mov_b32 v114, 0
    v_mov_b32 v115, 0
    v_mov_b32 v116, 0
    v_mov_b32 v117, 0
    v_mov_b32 v118, 0
    v_mov_b32 v119, 0
    v_mov_b32 v120, 0
    v_mov_b32 v121, 0
    v_mov_b32 v122, 0
    v_mov_b32 v123, 0
    v_mov_b32 v124, 0
    v_mov_b32 v125, 0
    v_mov_b32 v126, 0
    v_mov_b32 v127, 0
    v_mov_b32 v128, 0
    v_mov_b32 v129, 0
    v_mov_b32 v130, 0
    v_mov_b32 v131, 0
    v_mov_b32 v132, 0
    v_mov_b32 v133, 0
    v_mov_b32 v134, 0
    v_mov_b32 v135, 0
    v_mov_b32 v136, 0
    v_mov_b32 v137, 0
    v_mov_b32 v138, 0
    v_mov_b32 v139, 0
    v_mov_b32 v140, 0
    v_mov_b32 v141, 0
    v_mov_b32 v142, 0
    v_mov_b32 v143, 0
    v_mov_b32 v144, 0
    v_mov_b32 v145, 0
    v_mov_b32 v146, 0
    v_mov_b32 v147, 0
    v_mov_b32 v148, 0
    v_mov_b32 v149, 0
    v_mov_b32 v150, 0
    v_mov_b32 v151, 0
    v_mov_b32 v152, 0
    v_mov_b32 v153, 0
    v_mov_b32 v154, 0
    v_mov_b32 v155, 0
    v_mov_b32 v156, 0
    v_mov_b32 v157, 0
    v_mov_b32 v158, 0
    v_mov_b32 v159, 0
    v_mov_b32 v160, 0
    v_mov_b32 v161, 0
    v_mov_b32 v162, 0
    v_mov_b32 v163, 0
    v_mov_b32 v164, 0
    v_mov_b32 v165, 0
    v_mov_b32 v166, 0
    v_mov_b32 v167, 0
    v_mov_b32 v168, 0
    v_mov_b32 v169, 0
    v_mov_b32 v170, 0
    v_mov_b32 v171, 0
    v_mov_b32 v172, 0
    v_mov_b32 v173, 0
    v_mov_b32 v174, 0
    v_mov_b32 v175, 0
    v_mov_b32 v176, 0
    v_mov_b32 v177, 0
    v_mov_b32 v178, 0
    v_mov_b32 v179, 0
    v_mov_b32 v180, 0
    v_mov_b32 v181, 0
    v_mov_b32 v182, 0
    v_mov_b32 v183, 0
    v_mov_b32 v184, 0
    v_mov_b32 v185, 0
    v_mov_b32 v186, 0
    v_mov_b32 v187, 0
    v_mov_b32 v188, 0
    v_mov_b32 v189, 0
    v_mov_b32 v190, 0
    v_mov_b32 v191, 0
    v_mov_b32 v192, 0
    v_mov_b32 v193, 0
    v_mov_b32 v194, 0
    v_mov_b32 v195, 0
    v_mov_b32 v196, 0
    v_mov_b32 v197, 0
    v_mov_b32 v198, 0
    v_mov_b32 v199, 0
    v_mov_b32 v200, 0
    v_mov_b32 v201, 0
    v_mov_b32 v202, 0
    v_mov_b32 v203, 0
    v_mov_b32 v204, 0
    v_mov_b32 v205, 0
    v_mov_b32 v206, 0
    v_mov_b32 v207, 0
    v_mov_b32 v208, 0
    v_mov_b32 v209, 0
    v_mov_b32 v210, 0
    v_mov_b32 v211, 0
    v_mov_b32 v212, 0
    v_mov_b32 v213, 0
    v_mov_b32 v214, 0
    v_mov_b32 v215, 0
    v_mov_b32 v216, 0
    v_mov_b32 v217, 0
    v_mov_b32 v218, 0
    v_mov_b32 v219, 0
    v_mov_b32 v220, 0
    v_mov_b32 v221, 0
    v_mov_b32 v222, 0
    v_mov_b32 v223, 0
    v_mov_b32 v224, 0
    v_mov_b32 v225, 0
    v_mov_b32 v226, 0
    v_mov_b32 v227, 0
    v_mov_b32 v228, 0
    v_mov_b32 v229, 0
    v_mov_b32 v230, 0
    v_mov_b32 v231, 0
    v_mov_b32 v232, 0
    v_mov_b32 v233, 0
    v_mov_b32 v234, 0
    v_mov_b32 v235, 0
    v_mov_b32 v236, 0
    v_mov_b32 v237, 0
    v_mov_b32 v238, 0
    v_mov_b32 v239, 0
    v_mov_b32 v240, 0
    v_mov_b32 v241, 0
    v_mov_b32 v242, 0
    v_mov_b32 v243, 0
    v_mov_b32 v244, 0
    v_mov_b32 v245, 0
    v_mov_b32 v246, 0
    v_mov_b32 v247, 0
    v_mov_b32 v248, 0
    v_mov_b32 v249, 0
    v_mov_b32 v250, 0
    v_mov_b32 v251, 0
    v_mov_b32 v252, 0
    v_mov_b32 v253, 0
    v_mov_b32 v254, 0
    v_mov_b32 v255, 0
    v_bfe_u32 v4, v0, 1, 1
    v_lshrrev_b32 v3, 5, v0
    v_cmp_eq_u32 vcc, v3, v4
    v_mov_b32 v3, 0x3f803f80
    v_and_b32 v4, 1, v0
    v_cndmask_b32 v3, 0, v3, vcc
    v_mul_u32_u24 v4, 0xaaaa, v4
    v_add_u32 v60, 0x4444, v4
    v_accvgpr_write_b32 a228, v3
    v_accvgpr_write_b32 a229, v3
    v_accvgpr_write_b32 a230, v3
    v_accvgpr_write_b32 a231, v3
    v_accvgpr_write_b32 a208, 0
    v_accvgpr_write_b32 a209, 0
    v_accvgpr_write_b32 a210, 0
    v_accvgpr_write_b32 a211, 0
    v_accvgpr_write_b32 a212, 0
    v_accvgpr_write_b32 a213, 0
    v_accvgpr_write_b32 a214, 0
    v_accvgpr_write_b32 a215, 0
    v_accvgpr_write_b32 a216, 0
    v_accvgpr_write_b32 a217, 0
    v_accvgpr_write_b32 a218, 0
    v_accvgpr_write_b32 a219, 0
    v_accvgpr_write_b32 a220, 0
    v_accvgpr_write_b32 a221, 0
    v_accvgpr_write_b32 a222, 0
    v_accvgpr_write_b32 a223, 0
    v_accvgpr_write_b32 a224, 0
    v_accvgpr_write_b32 a225, 0
    v_accvgpr_write_b32 a226, 0
    v_accvgpr_write_b32 a227, 0
    s_waitcnt lgkmcnt(0)
    s_barrier
    s_mov_b32 s28, 49152
    s_add_u32 m0, s27, 49152
    s_nop 0
    buffer_load_dwordx4 v76, s[4:7], s28 offen offset:0 nt lds
    buffer_load_dwordx4 v77, s[4:7], s28 offen offset:1024 nt lds
    buffer_load_dwordx4 v78, s[4:7], s28 offen offset:2048 nt lds
    buffer_load_dwordx4 v79, s[4:7], s28 offen offset:3072 nt lds
    s_mov_b32 s28, 49152
    s_add_u32 m0, s27, 114688
    s_nop 0
    buffer_load_dwordx4 v80, s[8:11], s28 offen offset:0 nt lds
    buffer_load_dwordx4 v81, s[8:11], s28 offen offset:1024 nt lds
    buffer_load_dwordx4 v80, s[8:11], s28 offen offset:2048 nt lds
    buffer_load_dwordx4 v81, s[8:11], s28 offen offset:3072 nt lds
    v_mfma_f32_16x16x32_bf16 v[8:11], a[80:83], a[0:3], v[32:35]
    v_mfma_f32_16x16x32_bf16 v[8:11], a[84:87], a[4:7], v[8:11]
    v_mfma_f32_16x16x32_bf16 v[8:11], a[88:91], a[8:11], v[8:11]
    v_mfma_f32_16x16x32_bf16 v[8:11], a[92:95], a[12:15], v[8:11]
    v_mfma_f32_16x16x32_bf16 v[12:15], a[96:99], a[0:3], v[32:35]
    v_mfma_f32_16x16x32_bf16 v[12:15], a[100:103], a[4:7], v[12:15]
    v_mfma_f32_16x16x32_bf16 v[12:15], a[104:107], a[8:11], v[12:15]
    v_mfma_f32_16x16x32_bf16 v[12:15], a[108:111], a[12:15], v[12:15]
    v_mfma_f32_16x16x32_bf16 v[16:19], a[80:83], a[16:19], v[36:39]
    v_mfma_f32_16x16x32_bf16 v[16:19], a[84:87], a[20:23], v[16:19]
    v_mfma_f32_16x16x32_bf16 v[16:19], a[88:91], a[24:27], v[16:19]
    v_mfma_f32_16x16x32_bf16 v[16:19], a[92:95], a[28:31], v[16:19]
    v_mfma_f32_16x16x32_bf16 v[20:23], a[96:99], a[16:19], v[36:39]
    v_mfma_f32_16x16x32_bf16 v[20:23], a[100:103], a[20:23], v[20:23]
    v_mfma_f32_16x16x32_bf16 v[20:23], a[104:107], a[24:27], v[20:23]
    v_mfma_f32_16x16x32_bf16 v[20:23], a[108:111], a[28:31], v[20:23]
    v_exp_f32 v52, v8
    v_exp_f32 v53, v9
    v_exp_f32 v54, v10
    v_cvt_pk_bf16_f32 v24, v52, v53
    v_exp_f32 v55, v11
    v_exp_f32 v52, v12
    v_cvt_pk_bf16_f32 v25, v54, v55
    v_exp_f32 v53, v13
    v_exp_f32 v54, v14
    v_cvt_pk_bf16_f32 v26, v52, v53
    v_exp_f32 v55, v15
    s_nop 0
    v_cvt_pk_bf16_f32 v27, v54, v55
    s_mov_b32 s16, s20
    s_mov_b32 s17, s21
    s_lshr_b32 s96, s2, 3
    s_lshl2_add_u32 s96, s96, s26
    s_lshl_b32 s96, s96, 13
    v_lshl_add_u32 v6, v0, 7, s96
    s_mov_b32 s28, 65536
    s_mov_b32 s29, 0
    s_nop 7
    s_branch L_loop
L_code_end:
.section .rodata,"a"
.p2align 6
.amdhsa_kernel concat_heads__gqa_block_cached__gqa_block_cached__near_ridge_kernel
  .amdhsa_next_free_vgpr 512
  .amdhsa_next_free_sgpr 102
  .amdhsa_accum_offset 256
  .amdhsa_group_segment_fixed_size 0
  .amdhsa_kernarg_size 104
  .amdhsa_user_sgpr_count 2
  .amdhsa_user_sgpr_kernarg_segment_ptr 1
  .amdhsa_system_sgpr_workgroup_id_x 1
.end_amdhsa_kernel
```
